```python
import torch

def _softmax(x, axis=-1):
    return torch.softmax(x, dim=axis)
def _gelu(x):
    return torch.nn.functional.gelu(x, approximate="tanh")
def _silu(x):
    return torch.nn.functional.silu(x)
def _sigmoid(x):
    return torch.sigmoid(x)
def _layernorm(x, axis=-1, eps=1e-5):
    m = x.mean(dim=axis, keepdim=True)
    v = x.var(dim=axis, keepdim=True, unbiased=False)
    return (x - m) / torch.sqrt(v + eps)
def _scatter_add(tgt, idx, src, axis=0):
    return tgt.clone().index_add_(axis, idx, src)
def _segment_sum(src, seg, n):
    out = torch.zeros((n,) + src.shape[1:], dtype=src.dtype)
    return out.index_add_(0, seg, src)
def _pad(x, pw):
    flat = tuple(v for pair in reversed(pw) for v in pair)
    return torch.nn.functional.pad(x, flat)

kernel_name = 'sequential_preLN__softmax_full_mha__geglu_ffn__prompt'

def setup_inputs():

    _w = (lambda a: (lambda t: t.to(torch.bfloat16) if t.is_floating_point() else t)(torch.as_tensor(a)))
    def _A_setup():
        B, S, D = 1, 2048, 640
        return {
            "x": _w((lambda *s: torch.randn(*s, dtype=torch.bfloat16) * 0.05)(B, S, D)),
            "wqkv": _w((lambda *s: torch.randn(*s, dtype=torch.bfloat16) * 0.05)(D, 3 * D)),
            "wo": _w((lambda *s: torch.randn(*s, dtype=torch.bfloat16) * 0.05)(D, D)),
        }
    _A_in = _A_setup()

    def _B_setup():
        B, S, D, F = 1, 2048, 640, 1728
        return {
            "x": _w((lambda *s: torch.randn(*s, dtype=torch.bfloat16) * 0.05)(B, S, D)),
            "w_gate": _w((lambda *s: torch.randn(*s, dtype=torch.bfloat16) * 0.05)(D, F)),
            "w_up": _w((lambda *s: torch.randn(*s, dtype=torch.bfloat16) * 0.05)(D, F)),
            "w_down": _w((lambda *s: torch.randn(*s, dtype=torch.bfloat16) * 0.05)(F, D)),
        }
    _B_in = _B_setup()

    return {
        "A_x": _A_in["x"],
        "A_wqkv": _A_in["wqkv"],
        "A_wo": _A_in["wo"],
        "B_x": _B_in["x"],
        "B_w_gate": _B_in["w_gate"],
        "B_w_up": _B_in["w_up"],
        "B_w_down": _B_in["w_down"],
    }

def reference(A_x, A_wqkv, A_wo, B_x, B_w_gate, B_w_up, B_w_down):
    def _A_ref(x, wqkv, wo):
        B, S, D = x.shape
        H = 32; Dh = D // H
        qkv = (lambda x, *d: x.permute(*d))((x @ wqkv).reshape(B, S, 3, H, Dh), 2, 0, 3, 1, 4)
        q, k, v = qkv[0], qkv[1], qkv[2]
        scale = Dh ** -0.5
        scores = torch.einsum("bhqd,bhkd->bhqk", q, k) * scale
        p = _softmax(scores, axis=-1)
        o = torch.einsum("bhqk,bhkd->bhqd", p, v)
        return (lambda x, *d: x.permute(*d))(o, 0, 2, 1, 3).reshape(B, S, D) @ wo

    def _B_ref(x, w_gate, w_up, w_down):
        return (_gelu(x @ w_gate) * (x @ w_up)) @ w_down

    x = A_x
    h = x + _A_ref(_layernorm(x, axis=-1), A_wqkv, A_wo)
    h2 = h + _B_ref(_layernorm(h, axis=-1), B_w_gate, B_w_up, B_w_down)
    return h2
```

```asm
; @launch kernel=k1_kernel grid=(256,1,1) block=(512,1,1) lds=132608
; @launch kernel=k2_kernel grid=(256,1,1) block=(640,1,1) lds=163840
; @launch kernel=k3_kernel grid=(256,1,1) block=(640,1,1) lds=163840
.amdgcn_target "amdgcn-amd-amdhsa--gfx950"
.text
.p2align 8
.globl k1_kernel
.type k1_kernel,@function
k1_kernel:
    s_load_dwordx4 s[4:7], s[0:1], 0
    s_load_dwordx2 s[8:9], s[0:1], 72
    s_cmp_ge_u32 s2, 240
    s_cbranch_scc1 L_k1_side
    v_lshrrev_b32 v2, 6, v0
    v_and_b32 v1, 63, v0
    s_and_b32 s10, s2, 7
    v_readfirstlane_b32 s24, v2
    s_lshr_b32 s11, s2, 3
    s_and_b32 s33, s10, 1
    s_mul_i32 s33, s33, 30
    s_add_u32 s33, s33, s11
    s_lshr_b32 s26, s33, 2
    s_and_b32 s45, s33, 3
    s_lshr_b32 s10, s10, 1
    s_lshl_b32 s10, s10, 2
    s_add_u32 s25, s10, s45
    s_mov_b32 s14, 2621440
    s_mov_b32 s15, 0x20000
    s_mov_b32 s18, 2457600
    s_mov_b32 s19, 0x20000
    v_lshrrev_b32 v11, 4, v1
    s_mul_i32 s27, s25, 163840
    s_lshl_b32 s28, s26, 8
    s_cmp_lt_u32 s24, 4
    s_cbranch_scc1 L_k1_compute
    s_sub_u32 s24, s24, 4
    v_lshrrev_b32 v10, 3, v1
    s_lshl_b32 s33, s24, 5
    v_add_u32 v10, s33, v10
    v_mul_u32_u24 v10, 1280, v10
    v_and_b32 v12, 7, v1
    v_xor_b32 v12, v12, v11
    v_lshl_add_u32 v2, v12, 4, v10
    v_xor_b32 v12, 4, v12
    v_lshl_add_u32 v3, v12, 4, v10
    v_add_u32 v3, 9216, v3
    v_add_u32 v4, 18432, v2
    v_add_u32 v5, 18432, v3
    s_lshl_b32 s33, s24, 4
    v_add_u32 v13, s33, v11
    v_mul_u32_u24 v13, 3840, v13
    v_lshlrev_b32 v14, 2, v11
    v_and_b32 v12, 15, v1
    v_xor_b32 v12, v12, v14
    v_lshl_add_u32 v6, v12, 4, v13
    v_add_u32 v7, 14336, v6
    v_add_u32 v8, 28672, v6
    v_add_u32 v9, 43008, v6
    s_lshl_b32 s34, s24, 12
    s_add_u32 s35, s34, 16384
    s_mul_i32 s46, s45, 3
    s_mul_i32 s47, s26, 1
    s_add_u32 s46, s46, s47
    s_mul_i32 s47, s46, 205
    s_lshr_b32 s47, s47, 11
    s_mul_i32 s47, s47, 10
    s_sub_u32 s46, s46, s47
    s_lshl_b32 s47, s46, 7
    s_add_u32 s27, s27, s47
    s_mul_i32 s47, s46, 245760
    s_add_u32 s28, s28, s47
    s_setprio 2
    s_waitcnt lgkmcnt(0)
    s_mov_b32 s12, s4
    s_mov_b32 s13, s5
    s_mov_b32 s16, s6
    s_mov_b32 s17, s7
    s_add_u32 m0, s34, 0
    s_nop 0
    buffer_load_dwordx4 v2, s[12:15], s27 offen offset:0 lds
    buffer_load_dwordx4 v3, s[12:15], s27 offen offset:1024 lds
    buffer_load_dwordx4 v4, s[12:15], s27 offen offset:2048 lds
    buffer_load_dwordx4 v5, s[12:15], s27 offen offset:3072 lds
    s_add_u32 m0, s35, 0
    s_nop 0
    buffer_load_dwordx4 v6, s[16:19], s28 offen offset:0 lds
    s_add_u32 s46, s46, 1
    s_cmp_eq_u32 s46, 10
    s_cselect_b32 s46, 0, s46
    s_mov_b32 s47, 128
    s_cmov_b32 s47, 4294966144
    s_mov_b32 s48, 245760
    s_cmov_b32 s48, 4292755456
    s_add_u32 s27, s27, s47
    buffer_load_dwordx4 v7, s[16:19], s28 offen offset:1024 lds
    buffer_load_dwordx4 v8, s[16:19], s28 offen offset:2048 lds
    buffer_load_dwordx4 v9, s[16:19], s28 offen offset:3072 lds
    s_add_u32 s28, s28, s48
    s_add_u32 m0, s34, 32768
    s_nop 0
    buffer_load_dwordx4 v2, s[12:15], s27 offen offset:0 lds
    buffer_load_dwordx4 v3, s[12:15], s27 offen offset:1024 lds
    buffer_load_dwordx4 v4, s[12:15], s27 offen offset:2048 lds
    buffer_load_dwordx4 v5, s[12:15], s27 offen offset:3072 lds
    s_waitcnt vmcnt(4)
    s_barrier
    s_add_u32 m0, s35, 32768
    s_nop 0
    buffer_load_dwordx4 v6, s[16:19], s28 offen offset:0 lds
    s_add_u32 s46, s46, 1
    s_cmp_eq_u32 s46, 10
    s_cselect_b32 s46, 0, s46
    s_mov_b32 s47, 128
    s_cmov_b32 s47, 4294966144
    s_mov_b32 s48, 245760
    s_cmov_b32 s48, 4292755456
    s_add_u32 s27, s27, s47
    buffer_load_dwordx4 v7, s[16:19], s28 offen offset:1024 lds
    buffer_load_dwordx4 v8, s[16:19], s28 offen offset:2048 lds
    buffer_load_dwordx4 v9, s[16:19], s28 offen offset:3072 lds
    s_add_u32 s28, s28, s48
    s_add_u32 m0, s34, 98304
    s_nop 0
    buffer_load_dwordx4 v2, s[12:15], s27 offen offset:0 lds
    buffer_load_dwordx4 v3, s[12:15], s27 offen offset:1024 lds
    buffer_load_dwordx4 v4, s[12:15], s27 offen offset:2048 lds
    buffer_load_dwordx4 v5, s[12:15], s27 offen offset:3072 lds
    s_add_u32 m0, s35, 98304
    s_nop 0
    buffer_load_dwordx4 v6, s[16:19], s28 offen offset:0 lds
    s_add_u32 s46, s46, 1
    s_cmp_eq_u32 s46, 10
    s_cselect_b32 s46, 0, s46
    s_mov_b32 s47, 128
    s_cmov_b32 s47, 4294966144
    s_mov_b32 s48, 245760
    s_cmov_b32 s48, 4292755456
    s_add_u32 s27, s27, s47
    buffer_load_dwordx4 v7, s[16:19], s28 offen offset:1024 lds
    buffer_load_dwordx4 v8, s[16:19], s28 offen offset:2048 lds
    buffer_load_dwordx4 v9, s[16:19], s28 offen offset:3072 lds
    s_add_u32 s28, s28, s48
    s_waitcnt vmcnt(8)
    s_barrier
    s_add_u32 m0, s34, 65536
    s_nop 0
    buffer_load_dwordx4 v2, s[12:15], s27 offen offset:0 lds
    buffer_load_dwordx4 v3, s[12:15], s27 offen offset:1024 lds
    buffer_load_dwordx4 v4, s[12:15], s27 offen offset:2048 lds
    buffer_load_dwordx4 v5, s[12:15], s27 offen offset:3072 lds
    s_add_u32 m0, s35, 65536
    s_nop 0
    buffer_load_dwordx4 v6, s[16:19], s28 offen offset:0 lds
    s_add_u32 s46, s46, 1
    s_cmp_eq_u32 s46, 10
    s_cselect_b32 s46, 0, s46
    s_mov_b32 s47, 128
    s_cmov_b32 s47, 4294966144
    s_mov_b32 s48, 245760
    s_cmov_b32 s48, 4292755456
    s_add_u32 s27, s27, s47
    buffer_load_dwordx4 v7, s[16:19], s28 offen offset:1024 lds
    buffer_load_dwordx4 v8, s[16:19], s28 offen offset:2048 lds
    buffer_load_dwordx4 v9, s[16:19], s28 offen offset:3072 lds
    s_add_u32 s28, s28, s48
    s_add_u32 m0, s34, 0
    s_nop 0
    buffer_load_dwordx4 v2, s[12:15], s27 offen offset:0 lds
    buffer_load_dwordx4 v3, s[12:15], s27 offen offset:1024 lds
    buffer_load_dwordx4 v4, s[12:15], s27 offen offset:2048 lds
    buffer_load_dwordx4 v5, s[12:15], s27 offen offset:3072 lds
    s_add_u32 m0, s35, 0
    s_nop 0
    buffer_load_dwordx4 v6, s[16:19], s28 offen offset:0 lds
    s_add_u32 s46, s46, 1
    s_cmp_eq_u32 s46, 10
    s_cselect_b32 s46, 0, s46
    s_mov_b32 s47, 128
    s_cmov_b32 s47, 4294966144
    s_mov_b32 s48, 245760
    s_cmov_b32 s48, 4292755456
    s_add_u32 s27, s27, s47
    buffer_load_dwordx4 v7, s[16:19], s28 offen offset:1024 lds
    buffer_load_dwordx4 v8, s[16:19], s28 offen offset:2048 lds
    buffer_load_dwordx4 v9, s[16:19], s28 offen offset:3072 lds
    s_add_u32 s28, s28, s48
    s_add_u32 m0, s34, 32768
    s_waitcnt vmcnt(16)
    s_barrier
    buffer_load_dwordx4 v2, s[12:15], s27 offen offset:0 lds
    buffer_load_dwordx4 v3, s[12:15], s27 offen offset:1024 lds
    buffer_load_dwordx4 v4, s[12:15], s27 offen offset:2048 lds
    buffer_load_dwordx4 v5, s[12:15], s27 offen offset:3072 lds
    s_add_u32 m0, s35, 32768
    s_nop 0
    buffer_load_dwordx4 v6, s[16:19], s28 offen offset:0 lds
    s_add_u32 s46, s46, 1
    s_cmp_eq_u32 s46, 10
    s_cselect_b32 s46, 0, s46
    s_mov_b32 s47, 128
    s_cmov_b32 s47, 4294966144
    s_mov_b32 s48, 245760
    s_cmov_b32 s48, 4292755456
    s_add_u32 s27, s27, s47
    buffer_load_dwordx4 v7, s[16:19], s28 offen offset:1024 lds
    buffer_load_dwordx4 v8, s[16:19], s28 offen offset:2048 lds
    buffer_load_dwordx4 v9, s[16:19], s28 offen offset:3072 lds
    s_add_u32 s28, s28, s48
    s_add_u32 m0, s34, 98304
    s_waitcnt vmcnt(16)
    s_barrier
    buffer_load_dwordx4 v2, s[12:15], s27 offen offset:0 lds
    buffer_load_dwordx4 v3, s[12:15], s27 offen offset:1024 lds
    buffer_load_dwordx4 v4, s[12:15], s27 offen offset:2048 lds
    buffer_load_dwordx4 v5, s[12:15], s27 offen offset:3072 lds
    s_add_u32 m0, s35, 98304
    s_nop 0
    buffer_load_dwordx4 v6, s[16:19], s28 offen offset:0 lds
    s_add_u32 s46, s46, 1
    s_cmp_eq_u32 s46, 10
    s_cselect_b32 s46, 0, s46
    s_mov_b32 s47, 128
    s_cmov_b32 s47, 4294966144
    s_mov_b32 s48, 245760
    s_cmov_b32 s48, 4292755456
    s_add_u32 s27, s27, s47
    buffer_load_dwordx4 v7, s[16:19], s28 offen offset:1024 lds
    buffer_load_dwordx4 v8, s[16:19], s28 offen offset:2048 lds
    buffer_load_dwordx4 v9, s[16:19], s28 offen offset:3072 lds
    s_add_u32 s28, s28, s48
    s_add_u32 m0, s34, 65536
    s_waitcnt vmcnt(16)
    s_barrier
    buffer_load_dwordx4 v2, s[12:15], s27 offen offset:0 lds
    buffer_load_dwordx4 v3, s[12:15], s27 offen offset:1024 lds
    buffer_load_dwordx4 v4, s[12:15], s27 offen offset:2048 lds
    buffer_load_dwordx4 v5, s[12:15], s27 offen offset:3072 lds
    s_add_u32 m0, s35, 65536
    s_nop 0
    buffer_load_dwordx4 v6, s[16:19], s28 offen offset:0 lds
    s_add_u32 s46, s46, 1
    s_cmp_eq_u32 s46, 10
    s_cselect_b32 s46, 0, s46
    s_mov_b32 s47, 128
    s_cmov_b32 s47, 4294966144
    s_mov_b32 s48, 245760
    s_cmov_b32 s48, 4292755456
    s_add_u32 s27, s27, s47
    buffer_load_dwordx4 v7, s[16:19], s28 offen offset:1024 lds
    buffer_load_dwordx4 v8, s[16:19], s28 offen offset:2048 lds
    buffer_load_dwordx4 v9, s[16:19], s28 offen offset:3072 lds
    s_add_u32 s28, s28, s48
    s_add_u32 m0, s34, 0
    s_waitcnt vmcnt(16)
    s_barrier
    buffer_load_dwordx4 v2, s[12:15], s27 offen offset:0 lds
    buffer_load_dwordx4 v3, s[12:15], s27 offen offset:1024 lds
    buffer_load_dwordx4 v4, s[12:15], s27 offen offset:2048 lds
    buffer_load_dwordx4 v5, s[12:15], s27 offen offset:3072 lds
    s_add_u32 m0, s35, 0
    s_nop 0
    buffer_load_dwordx4 v6, s[16:19], s28 offen offset:0 lds
    s_add_u32 s46, s46, 1
    s_cmp_eq_u32 s46, 10
    s_cselect_b32 s46, 0, s46
    s_mov_b32 s47, 128
    s_cmov_b32 s47, 4294966144
    s_mov_b32 s48, 245760
    s_cmov_b32 s48, 4292755456
    s_add_u32 s27, s27, s47
    buffer_load_dwordx4 v7, s[16:19], s28 offen offset:1024 lds
    buffer_load_dwordx4 v8, s[16:19], s28 offen offset:2048 lds
    buffer_load_dwordx4 v9, s[16:19], s28 offen offset:3072 lds
    s_add_u32 s28, s28, s48
    s_add_u32 m0, s34, 32768
    s_waitcnt vmcnt(16)
    s_barrier
    buffer_load_dwordx4 v2, s[12:15], s27 offen offset:0 lds
    buffer_load_dwordx4 v3, s[12:15], s27 offen offset:1024 lds
    buffer_load_dwordx4 v4, s[12:15], s27 offen offset:2048 lds
    buffer_load_dwordx4 v5, s[12:15], s27 offen offset:3072 lds
    s_add_u32 m0, s35, 32768
    s_nop 0
    buffer_load_dwordx4 v6, s[16:19], s28 offen offset:0 lds
    s_add_u32 s46, s46, 1
    s_cmp_eq_u32 s46, 10
    s_cselect_b32 s46, 0, s46
    s_mov_b32 s47, 128
    s_cmov_b32 s47, 4294966144
    s_mov_b32 s48, 245760
    s_cmov_b32 s48, 4292755456
    s_add_u32 s27, s27, s47
    buffer_load_dwordx4 v7, s[16:19], s28 offen offset:1024 lds
    buffer_load_dwordx4 v8, s[16:19], s28 offen offset:2048 lds
    buffer_load_dwordx4 v9, s[16:19], s28 offen offset:3072 lds
    s_add_u32 s28, s28, s48
    s_waitcnt vmcnt(16)
    s_barrier
    v_lshlrev_b32 v20, 4, v1
    s_cmp_lg_u32 s24, 0
    s_cbranch_scc1 L_k1_nocpf2
    s_waitcnt vmcnt(8)
    s_barrier
    s_waitcnt vmcnt(0)
    s_barrier
    s_getpc_b64 s[46:47]
L_cpf1:
    s_add_u32 s46, s46, k2_kernel-L_cpf1
    s_addc_u32 s47, s47, 0
    global_load_dwordx4 v[24:27], v20, s[46:47] offset:0
    global_load_dwordx4 v[24:27], v20, s[46:47] offset:1024
    global_load_dwordx4 v[24:27], v20, s[46:47] offset:2048
    global_load_dwordx4 v[24:27], v20, s[46:47] offset:3072
    s_add_u32 s46, s46, 4096
    s_addc_u32 s47, s47, 0
    global_load_dwordx4 v[24:27], v20, s[46:47] offset:0
    global_load_dwordx4 v[24:27], v20, s[46:47] offset:1024
    s_endpgm
L_k1_nocpf2:
    s_waitcnt vmcnt(8)
    s_barrier
    s_waitcnt vmcnt(0)
    s_barrier
    s_endpgm
L_k1_compute:
    v_lshlrev_b32 v20, 4, v1
    s_cmp_lg_u32 s24, 0
    s_cbranch_scc1 L_k1_nocpf
    s_getpc_b64 s[46:47]
L_cpf2:
    s_add_u32 s46, s46, k1_kernel-L_cpf2
    s_addc_u32 s47, s47, -1
    global_load_dwordx4 v[160:163], v20, s[46:47] offset:0
    global_load_dwordx4 v[160:163], v20, s[46:47] offset:1024
    global_load_dwordx4 v[160:163], v20, s[46:47] offset:2048
    global_load_dwordx4 v[160:163], v20, s[46:47] offset:3072
    s_add_u32 s46, s46, 4096
    s_addc_u32 s47, s47, 0
    global_load_dwordx4 v[160:163], v20, s[46:47] offset:0
    global_load_dwordx4 v[160:163], v20, s[46:47] offset:1024
    global_load_dwordx4 v[160:163], v20, s[46:47] offset:2048
L_k1_nocpf:
    s_setprio 3
    s_lshr_b32 s36, s24, 1
    s_and_b32 s37, s24, 1
    v_and_b32 v56, 31, v1
    v_lshrrev_b32 v57, 5, v1
    v_lshrrev_b32 v58, 1, v56
    v_and_b32 v58, 7, v58
    v_xor_b32 v58, v58, v57
    s_lshl_b32 s33, s36, 13
    s_lshl_b32 s38, s37, 12
    s_add_u32 s33, s33, s38
    v_lshlrev_b32 v59, 7, v56
    v_add_u32 v59, s33, v59
    v_xor_b32 v60, 0, v58
    v_lshl_add_u32 v10, v60, 4, v59
    v_xor_b32 v14, 4096, v10
    v_xor_b32 v60, 2, v58
    v_lshl_add_u32 v11, v60, 4, v59
    v_xor_b32 v15, 4096, v11
    v_xor_b32 v60, 4, v58
    v_lshl_add_u32 v12, v60, 4, v59
    v_xor_b32 v16, 4096, v12
    v_xor_b32 v60, 6, v58
    v_lshl_add_u32 v13, v60, 4, v59
    v_xor_b32 v17, 4096, v13
    v_bfe_u32 v60, v1, 2, 2
    v_lshl_add_u32 v61, v57, 3, v60
    v_lshlrev_b32 v61, 8, v61
    v_bfe_u32 v62, v1, 4, 1
    v_bfe_u32 v63, v1, 1, 1
    v_lshl_add_u32 v62, v62, 1, v63
    s_lshl_b32 s33, s37, 1
    s_add_u32 s33, s33, s36
    v_xor_b32 v60, s33, v60
    v_lshl_add_u32 v62, v60, 2, v62
    v_lshl_add_u32 v61, v62, 4, v61
    v_and_b32 v63, 1, v1
    v_lshl_add_u32 v61, v63, 3, v61
    v_add_u32 v18, 16384, v61
    v_xor_b32 v19, 64, v18
    s_mov_b32 s29, 0
    s_mov_b32 s31, 0x8000
    s_mov_b32 s22, 10485760
    s_mov_b32 s23, 0x20000
    s_lshl_b32 s39, s36, 8
    s_lshl_b32 s33, s37, 7
    s_add_u32 s39, s39, s33
    s_lshl_b32 s40, s37, 8
    s_lshl_b32 s33, s36, 7
    s_add_u32 s40, s40, s33
    v_mov_b32 v152, 0x3f803f80
    v_mov_b32 v153, 0x3f803f80
    v_lshlrev_b32 v2, 2, v56
    v_lshlrev_b32 v3, 4, v57
    v_mov_b32 v64, 0
    v_mov_b32 v65, 0
    v_mov_b32 v66, 0
    v_mov_b32 v67, 0
    v_mov_b32 v68, 0
    v_mov_b32 v69, 0
    v_mov_b32 v70, 0
    v_mov_b32 v71, 0
    v_mov_b32 v72, 0
    v_mov_b32 v73, 0
    v_mov_b32 v74, 0
    v_mov_b32 v75, 0
    v_mov_b32 v76, 0
    v_mov_b32 v77, 0
    v_mov_b32 v78, 0
    v_mov_b32 v79, 0
    v_mov_b32 v80, 0
    v_mov_b32 v81, 0
    v_mov_b32 v82, 0
    v_mov_b32 v83, 0
    v_mov_b32 v84, 0
    v_mov_b32 v85, 0
    v_mov_b32 v86, 0
    v_mov_b32 v87, 0
    v_mov_b32 v88, 0
    v_mov_b32 v89, 0
    v_mov_b32 v90, 0
    v_mov_b32 v91, 0
    v_mov_b32 v92, 0
    v_mov_b32 v93, 0
    v_mov_b32 v94, 0
    v_mov_b32 v95, 0
    v_mov_b32 v96, 0
    v_mov_b32 v97, 0
    v_mov_b32 v98, 0
    v_mov_b32 v99, 0
    v_mov_b32 v100, 0
    v_mov_b32 v101, 0
    v_mov_b32 v102, 0
    v_mov_b32 v103, 0
    v_mov_b32 v104, 0
    v_mov_b32 v105, 0
    v_mov_b32 v106, 0
    v_mov_b32 v107, 0
    v_mov_b32 v108, 0
    v_mov_b32 v109, 0
    v_mov_b32 v110, 0
    v_mov_b32 v111, 0
    v_mov_b32 v112, 0
    v_mov_b32 v113, 0
    v_mov_b32 v114, 0
    v_mov_b32 v115, 0
    v_mov_b32 v116, 0
    v_mov_b32 v117, 0
    v_mov_b32 v118, 0
    v_mov_b32 v119, 0
    v_mov_b32 v120, 0
    v_mov_b32 v121, 0
    v_mov_b32 v122, 0
    v_mov_b32 v123, 0
    v_mov_b32 v124, 0
    v_mov_b32 v125, 0
    v_mov_b32 v126, 0
    v_mov_b32 v127, 0
    v_mov_b32 v140, 0
    v_mov_b32 v141, 0
    v_mov_b32 v142, 0
    v_mov_b32 v143, 0
    v_mov_b32 v144, 0
    v_mov_b32 v145, 0
    v_mov_b32 v146, 0
    v_mov_b32 v147, 0
    v_mov_b32 v148, 0
    v_mov_b32 v149, 0
    v_mov_b32 v150, 0
    v_mov_b32 v151, 0
    s_cmp_ge_u32 s26, 10
    s_cbranch_scc1 L_k1_setupV
    s_cmp_lt_u32 s26, 5
    s_cselect_b32 s41, 5242880, 0
    s_cselect_b32 s33, 0, 5
    s_sub_u32 s33, s26, s33
    s_lshl_b32 s33, s33, 5
    s_lshl_b32 s38, s37, 4
    s_add_u32 s33, s33, s38
    s_lshl_b32 s38, s36, 3
    s_add_u32 s33, s33, s38
    s_mul_i32 s38, s25, 10240
    s_add_u32 s41, s41, s38
    s_lshl_b32 s38, s39, 1
    s_add_u32 s42, s41, s38
    s_xor_b32 s38, s38, 256
    s_add_u32 s43, s41, s38
    v_add_u32 v6, s33, v57
    v_lshlrev_b32 v7, 3, v56
    s_mov_b32 s44, 158720
    v_add_u32 v4, s39, v2
    v_add_u32 v4, 131072, v4
    v_add_u32 v5, s40, v3
    v_add_u32 v5, 132096, v5
    v_xor_b32 v8, 0, v6
    v_mul_u32_u24 v9, 205, v8
    v_lshrrev_b32 v9, 10, v9
    v_lshl_add_u32 v8, v8, 10, v7
    v_mad_u32_u24 v128, v9, s44, v8
    v_xor_b32 v8, 0, v6
    v_add_u32 v8, 2, v8
    v_mul_u32_u24 v9, 205, v8
    v_lshrrev_b32 v9, 10, v9
    v_lshl_add_u32 v8, v8, 10, v7
    v_mad_u32_u24 v129, v9, s44, v8
    v_xor_b32 v8, 0, v6
    v_add_u32 v8, 4, v8
    v_mul_u32_u24 v9, 205, v8
    v_lshrrev_b32 v9, 10, v9
    v_lshl_add_u32 v8, v8, 10, v7
    v_mad_u32_u24 v130, v9, s44, v8
    v_xor_b32 v8, 0, v6
    v_add_u32 v8, 6, v8
    v_mul_u32_u24 v9, 205, v8
    v_lshrrev_b32 v9, 10, v9
    v_lshl_add_u32 v8, v8, 10, v7
    v_mad_u32_u24 v131, v9, s44, v8
    v_xor_b32 v8, 8, v6
    v_mul_u32_u24 v9, 205, v8
    v_lshrrev_b32 v9, 10, v9
    v_lshl_add_u32 v8, v8, 10, v7
    v_mad_u32_u24 v132, v9, s44, v8
    v_xor_b32 v8, 8, v6
    v_add_u32 v8, 2, v8
    v_mul_u32_u24 v9, 205, v8
    v_lshrrev_b32 v9, 10, v9
    v_lshl_add_u32 v8, v8, 10, v7
    v_mad_u32_u24 v133, v9, s44, v8
    v_xor_b32 v8, 8, v6
    v_add_u32 v8, 4, v8
    v_mul_u32_u24 v9, 205, v8
    v_lshrrev_b32 v9, 10, v9
    v_lshl_add_u32 v8, v8, 10, v7
    v_mad_u32_u24 v134, v9, s44, v8
    v_xor_b32 v8, 8, v6
    v_add_u32 v8, 6, v8
    v_mul_u32_u24 v9, 205, v8
    v_lshrrev_b32 v9, 10, v9
    v_lshl_add_u32 v8, v8, 10, v7
    v_mad_u32_u24 v135, v9, s44, v8
    s_waitcnt lgkmcnt(0)
    s_mov_b32 s20, s8
    s_mov_b32 s21, s9
    s_barrier
    ds_read_b128 v[24:27], v10
    ds_read_b64_tr_b16 v[32:33], v18 offset:0
    ds_read_b64_tr_b16 v[34:35], v18 offset:1024
    ds_read_b64_tr_b16 v[36:37], v19 offset:0
    ds_read_b64_tr_b16 v[38:39], v19 offset:1024
    ds_read_b128 v[28:31], v14
.p2align 6
L_k1_loopQ:
    ds_read_b128 v[40:43], v11
    ds_read_b64_tr_b16 v[48:49], v18 offset:4096
    s_waitcnt lgkmcnt(5)
    v_mfma_f32_32x32x16_bf16 v[64:79], v[32:35], v[24:27], v[64:79]
    ds_read_b64_tr_b16 v[50:51], v18 offset:5120
    ds_read_b64_tr_b16 v[52:53], v19 offset:4096
    v_mfma_f32_4x4x4_16b_bf16 v[140:143], v[24:25], v[152:153], v[140:143]
    v_mfma_f32_4x4x4_16b_bf16 v[144:147], v[24:25], v[24:25], v[144:147]
    v_mfma_f32_4x4x4_16b_bf16 v[148:151], v[32:33], v[152:153], v[148:151]
    s_waitcnt lgkmcnt(5)
    v_mfma_f32_32x32x16_bf16 v[80:95], v[36:39], v[24:27], v[80:95]
    ds_read_b64_tr_b16 v[54:55], v19 offset:5120
    ds_read_b128 v[44:47], v15
    v_mfma_f32_4x4x4_16b_bf16 v[140:143], v[26:27], v[152:153], v[140:143]
    v_mfma_f32_4x4x4_16b_bf16 v[144:147], v[26:27], v[26:27], v[144:147]
    v_mfma_f32_4x4x4_16b_bf16 v[148:151], v[34:35], v[152:153], v[148:151]
    s_waitcnt lgkmcnt(6)
    v_mfma_f32_32x32x16_bf16 v[96:111], v[32:35], v[28:31], v[96:111]
    v_xor_b32 v10, s31, v10
    v_xor_b32 v14, s31, v14
    v_mfma_f32_32x32x16_bf16 v[112:127], v[36:39], v[28:31], v[112:127]
    ds_read_b128 v[24:27], v12
    ds_read_b64_tr_b16 v[32:33], v18 offset:8192
    s_waitcnt lgkmcnt(5)
    v_mfma_f32_32x32x16_bf16 v[64:79], v[48:51], v[40:43], v[64:79]
    ds_read_b64_tr_b16 v[34:35], v18 offset:9216
    ds_read_b64_tr_b16 v[36:37], v19 offset:8192
    v_mfma_f32_4x4x4_16b_bf16 v[140:143], v[40:41], v[152:153], v[140:143]
    v_mfma_f32_4x4x4_16b_bf16 v[144:147], v[40:41], v[40:41], v[144:147]
    v_mfma_f32_4x4x4_16b_bf16 v[148:151], v[48:49], v[152:153], v[148:151]
    s_waitcnt lgkmcnt(5)
    v_mfma_f32_32x32x16_bf16 v[80:95], v[52:55], v[40:43], v[80:95]
    ds_read_b64_tr_b16 v[38:39], v19 offset:9216
    ds_read_b128 v[28:31], v16
    v_mfma_f32_4x4x4_16b_bf16 v[140:143], v[42:43], v[152:153], v[140:143]
    v_mfma_f32_4x4x4_16b_bf16 v[144:147], v[42:43], v[42:43], v[144:147]
    v_mfma_f32_4x4x4_16b_bf16 v[148:151], v[50:51], v[152:153], v[148:151]
    s_waitcnt lgkmcnt(6)
    v_mfma_f32_32x32x16_bf16 v[96:111], v[48:51], v[44:47], v[96:111]
    v_xor_b32 v11, s31, v11
    v_xor_b32 v15, s31, v15
    v_mfma_f32_32x32x16_bf16 v[112:127], v[52:55], v[44:47], v[112:127]
    ds_read_b128 v[40:43], v13
    ds_read_b64_tr_b16 v[48:49], v18 offset:12288
    s_waitcnt lgkmcnt(5)
    v_mfma_f32_32x32x16_bf16 v[64:79], v[32:35], v[24:27], v[64:79]
    ds_read_b64_tr_b16 v[50:51], v18 offset:13312
    ds_read_b64_tr_b16 v[52:53], v19 offset:12288
    v_mfma_f32_4x4x4_16b_bf16 v[140:143], v[24:25], v[152:153], v[140:143]
    v_mfma_f32_4x4x4_16b_bf16 v[144:147], v[24:25], v[24:25], v[144:147]
    v_mfma_f32_4x4x4_16b_bf16 v[148:151], v[32:33], v[152:153], v[148:151]
    s_waitcnt lgkmcnt(5)
    v_mfma_f32_32x32x16_bf16 v[80:95], v[36:39], v[24:27], v[80:95]
    ds_read_b64_tr_b16 v[54:55], v19 offset:13312
    ds_read_b128 v[44:47], v17
    v_mfma_f32_4x4x4_16b_bf16 v[140:143], v[26:27], v[152:153], v[140:143]
    v_mfma_f32_4x4x4_16b_bf16 v[144:147], v[26:27], v[26:27], v[144:147]
    v_mfma_f32_4x4x4_16b_bf16 v[148:151], v[34:35], v[152:153], v[148:151]
    s_waitcnt lgkmcnt(6)
    v_mfma_f32_32x32x16_bf16 v[96:111], v[32:35], v[28:31], v[96:111]
    v_xor_b32 v12, s31, v12
    v_xor_b32 v16, s31, v16
    v_mfma_f32_32x32x16_bf16 v[112:127], v[36:39], v[28:31], v[112:127]
    s_waitcnt lgkmcnt(3)
    v_mfma_f32_32x32x16_bf16 v[64:79], v[48:51], v[40:43], v[64:79]
    v_xor_b32 v18, s31, v18
    v_xor_b32 v19, s31, v19
    v_mfma_f32_4x4x4_16b_bf16 v[140:143], v[40:41], v[152:153], v[140:143]
    v_mfma_f32_4x4x4_16b_bf16 v[144:147], v[40:41], v[40:41], v[144:147]
    v_mfma_f32_4x4x4_16b_bf16 v[148:151], v[48:49], v[152:153], v[148:151]
    s_waitcnt lgkmcnt(0)
    v_mfma_f32_32x32x16_bf16 v[80:95], v[52:55], v[40:43], v[80:95]
    s_barrier
    ds_read_b128 v[24:27], v10
    ds_read_b64_tr_b16 v[32:33], v18 offset:0
    ds_read_b64_tr_b16 v[34:35], v18 offset:1024
    v_mfma_f32_4x4x4_16b_bf16 v[140:143], v[42:43], v[152:153], v[140:143]
    v_mfma_f32_4x4x4_16b_bf16 v[144:147], v[42:43], v[42:43], v[144:147]
    v_mfma_f32_4x4x4_16b_bf16 v[148:151], v[50:51], v[152:153], v[148:151]
    v_mfma_f32_32x32x16_bf16 v[96:111], v[48:51], v[44:47], v[96:111]
    ds_read_b64_tr_b16 v[36:37], v19 offset:0
    ds_read_b64_tr_b16 v[38:39], v19 offset:1024
    ds_read_b128 v[28:31], v14
    v_xor_b32 v13, s31, v13
    v_xor_b32 v17, s31, v17
    v_mfma_f32_32x32x16_bf16 v[112:127], v[52:55], v[44:47], v[112:127]
    s_xor_b32 s31, s31, 0x18000
    s_add_u32 s29, s29, 1
    s_cmp_lt_u32 s29, 10
    s_cbranch_scc1 L_k1_loopQ
    s_mov_b32 s46, 0x22222222
    s_mov_b32 s47, 0x22222222
    s_mov_b32 s48, 0x44444444
    s_mov_b32 s49, 0x44444444
    s_mov_b32 s50, 0x88888888
    s_mov_b32 s51, 0x88888888
    v_cndmask_b32 v20, v140, v141, s[46:47]
    v_cndmask_b32 v21, v144, v145, s[46:47]
    v_cndmask_b32 v22, v148, v149, s[46:47]
    v_cndmask_b32 v20, v20, v142, s[48:49]
    v_cndmask_b32 v21, v21, v146, s[48:49]
    v_cndmask_b32 v22, v22, v150, s[48:49]
    v_cndmask_b32 v20, v20, v143, s[50:51]
    v_cndmask_b32 v21, v21, v147, s[50:51]
    v_cndmask_b32 v22, v22, v151, s[50:51]
    v_mov_b32 v60, v20
    v_mov_b32 v61, v21
    v_mov_b32 v62, v22
    v_permlane32_swap_b32 v60, v20
    v_permlane32_swap_b32 v61, v21
    v_permlane32_swap_b32 v62, v22
    v_add_f32 v20, v20, v60
    v_add_f32 v21, v21, v61
    v_add_f32 v22, v22, v62
    v_mul_f32 v20, 0xbacccccd, v20
    v_mul_f32 v21, 0x3acccccd, v21
    v_fma_f32 v21, -v20, v20, v21
    v_max_f32 v21, 0, v21
    v_add_f32 v21, 0x3727c5ac, v21
    v_rsq_f32 v21, v21
    v_add_u32 v60, s39, v2
    v_add_u32 v61, s40, v2
    v_add_u32 v60, 131072, v60
    v_add_u32 v61, 132096, v61
    s_cmp_lt_u32 s26, 5
    s_cselect_b32 s33, 0x3ea52b5c, 1.0
    v_mul_f32 v21, s33, v21
    ds_write_b32 v60, v21
    ds_write_b32 v60, v20 offset:512
    ds_write_b32 v61, v22
    v_xor_b32 v6, 128, v4
    v_xor_b32 v7, 128, v5
    s_waitcnt lgkmcnt(0)
    s_barrier
    ds_read_b32 v136, v4
    ds_read_b32 v137, v4 offset:512
    ds_read_b32 v138, v6
    ds_read_b32 v139, v6 offset:512
    ds_read_b128 v[24:27], v5 offset:0
    ds_read_b128 v[28:31], v5 offset:32
    ds_read_b128 v[32:35], v5 offset:64
    ds_read_b128 v[36:39], v5 offset:96
    ds_read_b128 v[40:43], v7 offset:0
    ds_read_b128 v[44:47], v7 offset:32
    ds_read_b128 v[48:51], v7 offset:64
    ds_read_b128 v[52:55], v7 offset:96
    s_waitcnt lgkmcnt(4)
    v_pk_fma_f32 v[64:65], v[24:25], v[136:137], v[64:65] op_sel:[0,1,0] op_sel_hi:[1,1,1]
    v_pk_fma_f32 v[66:67], v[26:27], v[136:137], v[66:67] op_sel:[0,1,0] op_sel_hi:[1,1,1]
    v_pk_mul_f32 v[64:65], v[64:65], v[136:137] op_sel:[0,0] op_sel_hi:[1,0]
    v_pk_mul_f32 v[66:67], v[66:67], v[136:137] op_sel:[0,0] op_sel_hi:[1,0]
    v_cvt_pk_bf16_f32 v64, v64, v65
    v_cvt_pk_bf16_f32 v65, v66, v67
    buffer_store_dwordx2 v[64:65], v128, s[20:23], s42 offen
    v_pk_fma_f32 v[68:69], v[28:29], v[136:137], v[68:69] op_sel:[0,1,0] op_sel_hi:[1,1,1]
    v_pk_fma_f32 v[70:71], v[30:31], v[136:137], v[70:71] op_sel:[0,1,0] op_sel_hi:[1,1,1]
    v_pk_mul_f32 v[68:69], v[68:69], v[136:137] op_sel:[0,0] op_sel_hi:[1,0]
    v_pk_mul_f32 v[70:71], v[70:71], v[136:137] op_sel:[0,0] op_sel_hi:[1,0]
    v_cvt_pk_bf16_f32 v68, v68, v69
    v_cvt_pk_bf16_f32 v69, v70, v71
    buffer_store_dwordx2 v[68:69], v129, s[20:23], s42 offen
    v_pk_fma_f32 v[72:73], v[32:33], v[136:137], v[72:73] op_sel:[0,1,0] op_sel_hi:[1,1,1]
    v_pk_fma_f32 v[74:75], v[34:35], v[136:137], v[74:75] op_sel:[0,1,0] op_sel_hi:[1,1,1]
    v_pk_mul_f32 v[72:73], v[72:73], v[136:137] op_sel:[0,0] op_sel_hi:[1,0]
    v_pk_mul_f32 v[74:75], v[74:75], v[136:137] op_sel:[0,0] op_sel_hi:[1,0]
    v_cvt_pk_bf16_f32 v72, v72, v73
    v_cvt_pk_bf16_f32 v73, v74, v75
    buffer_store_dwordx2 v[72:73], v130, s[20:23], s42 offen
    v_pk_fma_f32 v[76:77], v[36:37], v[136:137], v[76:77] op_sel:[0,1,0] op_sel_hi:[1,1,1]
    v_pk_fma_f32 v[78:79], v[38:39], v[136:137], v[78:79] op_sel:[0,1,0] op_sel_hi:[1,1,1]
    v_pk_mul_f32 v[76:77], v[76:77], v[136:137] op_sel:[0,0] op_sel_hi:[1,0]
    v_pk_mul_f32 v[78:79], v[78:79], v[136:137] op_sel:[0,0] op_sel_hi:[1,0]
    v_cvt_pk_bf16_f32 v76, v76, v77
    v_cvt_pk_bf16_f32 v77, v78, v79
    buffer_store_dwordx2 v[76:77], v131, s[20:23], s42 offen
    v_pk_fma_f32 v[96:97], v[24:25], v[138:139], v[96:97] op_sel:[0,1,0] op_sel_hi:[1,1,1]
    v_pk_fma_f32 v[98:99], v[26:27], v[138:139], v[98:99] op_sel:[0,1,0] op_sel_hi:[1,1,1]
    v_pk_mul_f32 v[96:97], v[96:97], v[138:139] op_sel:[0,0] op_sel_hi:[1,0]
    v_pk_mul_f32 v[98:99], v[98:99], v[138:139] op_sel:[0,0] op_sel_hi:[1,0]
    v_cvt_pk_bf16_f32 v96, v96, v97
    v_cvt_pk_bf16_f32 v97, v98, v99
    buffer_store_dwordx2 v[96:97], v128, s[20:23], s43 offen
    v_pk_fma_f32 v[100:101], v[28:29], v[138:139], v[100:101] op_sel:[0,1,0] op_sel_hi:[1,1,1]
    v_pk_fma_f32 v[102:103], v[30:31], v[138:139], v[102:103] op_sel:[0,1,0] op_sel_hi:[1,1,1]
    v_pk_mul_f32 v[100:101], v[100:101], v[138:139] op_sel:[0,0] op_sel_hi:[1,0]
    v_pk_mul_f32 v[102:103], v[102:103], v[138:139] op_sel:[0,0] op_sel_hi:[1,0]
    v_cvt_pk_bf16_f32 v100, v100, v101
    v_cvt_pk_bf16_f32 v101, v102, v103
    buffer_store_dwordx2 v[100:101], v129, s[20:23], s43 offen
    v_pk_fma_f32 v[104:105], v[32:33], v[138:139], v[104:105] op_sel:[0,1,0] op_sel_hi:[1,1,1]
    v_pk_fma_f32 v[106:107], v[34:35], v[138:139], v[106:107] op_sel:[0,1,0] op_sel_hi:[1,1,1]
    v_pk_mul_f32 v[104:105], v[104:105], v[138:139] op_sel:[0,0] op_sel_hi:[1,0]
    v_pk_mul_f32 v[106:107], v[106:107], v[138:139] op_sel:[0,0] op_sel_hi:[1,0]
    v_cvt_pk_bf16_f32 v104, v104, v105
    v_cvt_pk_bf16_f32 v105, v106, v107
    buffer_store_dwordx2 v[104:105], v130, s[20:23], s43 offen
    v_pk_fma_f32 v[108:109], v[36:37], v[138:139], v[108:109] op_sel:[0,1,0] op_sel_hi:[1,1,1]
    v_pk_fma_f32 v[110:111], v[38:39], v[138:139], v[110:111] op_sel:[0,1,0] op_sel_hi:[1,1,1]
    v_pk_mul_f32 v[108:109], v[108:109], v[138:139] op_sel:[0,0] op_sel_hi:[1,0]
    v_pk_mul_f32 v[110:111], v[110:111], v[138:139] op_sel:[0,0] op_sel_hi:[1,0]
    v_cvt_pk_bf16_f32 v108, v108, v109
    v_cvt_pk_bf16_f32 v109, v110, v111
    buffer_store_dwordx2 v[108:109], v131, s[20:23], s43 offen
    s_waitcnt lgkmcnt(0)
    v_pk_fma_f32 v[80:81], v[40:41], v[136:137], v[80:81] op_sel:[0,1,0] op_sel_hi:[1,1,1]
    v_pk_fma_f32 v[82:83], v[42:43], v[136:137], v[82:83] op_sel:[0,1,0] op_sel_hi:[1,1,1]
    v_pk_mul_f32 v[80:81], v[80:81], v[136:137] op_sel:[0,0] op_sel_hi:[1,0]
    v_pk_mul_f32 v[82:83], v[82:83], v[136:137] op_sel:[0,0] op_sel_hi:[1,0]
    v_cvt_pk_bf16_f32 v80, v80, v81
    v_cvt_pk_bf16_f32 v81, v82, v83
    buffer_store_dwordx2 v[80:81], v132, s[20:23], s42 offen
    v_pk_fma_f32 v[84:85], v[44:45], v[136:137], v[84:85] op_sel:[0,1,0] op_sel_hi:[1,1,1]
    v_pk_fma_f32 v[86:87], v[46:47], v[136:137], v[86:87] op_sel:[0,1,0] op_sel_hi:[1,1,1]
    v_pk_mul_f32 v[84:85], v[84:85], v[136:137] op_sel:[0,0] op_sel_hi:[1,0]
    v_pk_mul_f32 v[86:87], v[86:87], v[136:137] op_sel:[0,0] op_sel_hi:[1,0]
    v_cvt_pk_bf16_f32 v84, v84, v85
    v_cvt_pk_bf16_f32 v85, v86, v87
    buffer_store_dwordx2 v[84:85], v133, s[20:23], s42 offen
    v_pk_fma_f32 v[88:89], v[48:49], v[136:137], v[88:89] op_sel:[0,1,0] op_sel_hi:[1,1,1]
    v_pk_fma_f32 v[90:91], v[50:51], v[136:137], v[90:91] op_sel:[0,1,0] op_sel_hi:[1,1,1]
    v_pk_mul_f32 v[88:89], v[88:89], v[136:137] op_sel:[0,0] op_sel_hi:[1,0]
    v_pk_mul_f32 v[90:91], v[90:91], v[136:137] op_sel:[0,0] op_sel_hi:[1,0]
    v_cvt_pk_bf16_f32 v88, v88, v89
    v_cvt_pk_bf16_f32 v89, v90, v91
    buffer_store_dwordx2 v[88:89], v134, s[20:23], s42 offen
    v_pk_fma_f32 v[92:93], v[52:53], v[136:137], v[92:93] op_sel:[0,1,0] op_sel_hi:[1,1,1]
    v_pk_fma_f32 v[94:95], v[54:55], v[136:137], v[94:95] op_sel:[0,1,0] op_sel_hi:[1,1,1]
    v_pk_mul_f32 v[92:93], v[92:93], v[136:137] op_sel:[0,0] op_sel_hi:[1,0]
    v_pk_mul_f32 v[94:95], v[94:95], v[136:137] op_sel:[0,0] op_sel_hi:[1,0]
    v_cvt_pk_bf16_f32 v92, v92, v93
    v_cvt_pk_bf16_f32 v93, v94, v95
    buffer_store_dwordx2 v[92:93], v135, s[20:23], s42 offen
    v_pk_fma_f32 v[112:113], v[40:41], v[138:139], v[112:113] op_sel:[0,1,0] op_sel_hi:[1,1,1]
    v_pk_fma_f32 v[114:115], v[42:43], v[138:139], v[114:115] op_sel:[0,1,0] op_sel_hi:[1,1,1]
    v_pk_mul_f32 v[112:113], v[112:113], v[138:139] op_sel:[0,0] op_sel_hi:[1,0]
    v_pk_mul_f32 v[114:115], v[114:115], v[138:139] op_sel:[0,0] op_sel_hi:[1,0]
    v_cvt_pk_bf16_f32 v112, v112, v113
    v_cvt_pk_bf16_f32 v113, v114, v115
    buffer_store_dwordx2 v[112:113], v132, s[20:23], s43 offen
    v_pk_fma_f32 v[116:117], v[44:45], v[138:139], v[116:117] op_sel:[0,1,0] op_sel_hi:[1,1,1]
    v_pk_fma_f32 v[118:119], v[46:47], v[138:139], v[118:119] op_sel:[0,1,0] op_sel_hi:[1,1,1]
    v_pk_mul_f32 v[116:117], v[116:117], v[138:139] op_sel:[0,0] op_sel_hi:[1,0]
    v_pk_mul_f32 v[118:119], v[118:119], v[138:139] op_sel:[0,0] op_sel_hi:[1,0]
    v_cvt_pk_bf16_f32 v116, v116, v117
    v_cvt_pk_bf16_f32 v117, v118, v119
    buffer_store_dwordx2 v[116:117], v133, s[20:23], s43 offen
    v_pk_fma_f32 v[120:121], v[48:49], v[138:139], v[120:121] op_sel:[0,1,0] op_sel_hi:[1,1,1]
    v_pk_fma_f32 v[122:123], v[50:51], v[138:139], v[122:123] op_sel:[0,1,0] op_sel_hi:[1,1,1]
    v_pk_mul_f32 v[120:121], v[120:121], v[138:139] op_sel:[0,0] op_sel_hi:[1,0]
    v_pk_mul_f32 v[122:123], v[122:123], v[138:139] op_sel:[0,0] op_sel_hi:[1,0]
    v_cvt_pk_bf16_f32 v120, v120, v121
    v_cvt_pk_bf16_f32 v121, v122, v123
    buffer_store_dwordx2 v[120:121], v134, s[20:23], s43 offen
    v_pk_fma_f32 v[124:125], v[52:53], v[138:139], v[124:125] op_sel:[0,1,0] op_sel_hi:[1,1,1]
    v_pk_fma_f32 v[126:127], v[54:55], v[138:139], v[126:127] op_sel:[0,1,0] op_sel_hi:[1,1,1]
    v_pk_mul_f32 v[124:125], v[124:125], v[138:139] op_sel:[0,0] op_sel_hi:[1,0]
    v_pk_mul_f32 v[126:127], v[126:127], v[138:139] op_sel:[0,0] op_sel_hi:[1,0]
    v_cvt_pk_bf16_f32 v124, v124, v125
    v_cvt_pk_bf16_f32 v125, v126, v127
    buffer_store_dwordx2 v[124:125], v135, s[20:23], s43 offen
    s_endpgm
L_k1_setupV:
    s_sub_u32 s33, s26, 10
    s_lshl_b32 s33, s33, 7
    s_lshr_b32 s38, s40, 2
    s_add_u32 s33, s33, s38
    v_add_u32 v6, s33, v56
    s_mul_i32 s41, s25, 10240
    s_add_u32 s41, s41, 5120
    s_lshr_b32 s38, s39, 7
    s_mul_i32 s42, s38, 1280
    s_add_u32 s42, s42, s41
    s_xor_b32 s38, s38, 1
    s_mul_i32 s43, s38, 1280
    s_add_u32 s43, s43, s41
    s_mov_b32 s44, 163520
    v_mul_u32_u24 v7, 320, v57
    v_add_u32 v4, s40, v2
    v_add_u32 v4, 132096, v4
    v_add_u32 v5, s39, v3
    v_add_u32 v5, 131072, v5
    v_xor_b32 v8, 0, v6
    v_mul_u32_u24 v9, 3277, v8
    v_lshrrev_b32 v9, 16, v9
    v_lshl_add_u32 v8, v8, 4, v7
    v_mad_u32_u24 v128, v9, s44, v8
    v_xor_b32 v8, 32, v6
    v_mul_u32_u24 v9, 3277, v8
    v_lshrrev_b32 v9, 16, v9
    v_lshl_add_u32 v8, v8, 4, v7
    v_mad_u32_u24 v129, v9, s44, v8
    s_waitcnt lgkmcnt(0)
    s_mov_b32 s20, s8
    s_mov_b32 s21, s9
    s_barrier
    ds_read_b128 v[24:27], v10
    ds_read_b64_tr_b16 v[32:33], v18 offset:0
    ds_read_b64_tr_b16 v[34:35], v18 offset:1024
    ds_read_b64_tr_b16 v[36:37], v19 offset:0
    ds_read_b64_tr_b16 v[38:39], v19 offset:1024
    ds_read_b128 v[28:31], v14
.p2align 6
L_k1_loopV:
    ds_read_b128 v[40:43], v11
    ds_read_b64_tr_b16 v[48:49], v18 offset:4096
    s_waitcnt lgkmcnt(5)
    v_mfma_f32_32x32x16_bf16 v[64:79], v[24:27], v[32:35], v[64:79]
    ds_read_b64_tr_b16 v[50:51], v18 offset:5120
    ds_read_b64_tr_b16 v[52:53], v19 offset:4096
    v_mfma_f32_4x4x4_16b_bf16 v[140:143], v[24:25], v[152:153], v[140:143]
    v_mfma_f32_4x4x4_16b_bf16 v[144:147], v[24:25], v[24:25], v[144:147]
    v_mfma_f32_4x4x4_16b_bf16 v[148:151], v[32:33], v[152:153], v[148:151]
    s_waitcnt lgkmcnt(5)
    v_mfma_f32_32x32x16_bf16 v[80:95], v[24:27], v[36:39], v[80:95]
    ds_read_b64_tr_b16 v[54:55], v19 offset:5120
    ds_read_b128 v[44:47], v15
    v_mfma_f32_4x4x4_16b_bf16 v[140:143], v[26:27], v[152:153], v[140:143]
    v_mfma_f32_4x4x4_16b_bf16 v[144:147], v[26:27], v[26:27], v[144:147]
    v_mfma_f32_4x4x4_16b_bf16 v[148:151], v[34:35], v[152:153], v[148:151]
    s_waitcnt lgkmcnt(6)
    v_mfma_f32_32x32x16_bf16 v[96:111], v[28:31], v[32:35], v[96:111]
    v_xor_b32 v10, s31, v10
    v_xor_b32 v14, s31, v14
    v_mfma_f32_32x32x16_bf16 v[112:127], v[28:31], v[36:39], v[112:127]
    ds_read_b128 v[24:27], v12
    ds_read_b64_tr_b16 v[32:33], v18 offset:8192
    s_waitcnt lgkmcnt(5)
    v_mfma_f32_32x32x16_bf16 v[64:79], v[40:43], v[48:51], v[64:79]
    ds_read_b64_tr_b16 v[34:35], v18 offset:9216
    ds_read_b64_tr_b16 v[36:37], v19 offset:8192
    v_mfma_f32_4x4x4_16b_bf16 v[140:143], v[40:41], v[152:153], v[140:143]
    v_mfma_f32_4x4x4_16b_bf16 v[144:147], v[40:41], v[40:41], v[144:147]
    v_mfma_f32_4x4x4_16b_bf16 v[148:151], v[48:49], v[152:153], v[148:151]
    s_waitcnt lgkmcnt(5)
    v_mfma_f32_32x32x16_bf16 v[80:95], v[40:43], v[52:55], v[80:95]
    ds_read_b64_tr_b16 v[38:39], v19 offset:9216
    ds_read_b128 v[28:31], v16
    v_mfma_f32_4x4x4_16b_bf16 v[140:143], v[42:43], v[152:153], v[140:143]
    v_mfma_f32_4x4x4_16b_bf16 v[144:147], v[42:43], v[42:43], v[144:147]
    v_mfma_f32_4x4x4_16b_bf16 v[148:151], v[50:51], v[152:153], v[148:151]
    s_waitcnt lgkmcnt(6)
    v_mfma_f32_32x32x16_bf16 v[96:111], v[44:47], v[48:51], v[96:111]
    v_xor_b32 v11, s31, v11
    v_xor_b32 v15, s31, v15
    v_mfma_f32_32x32x16_bf16 v[112:127], v[44:47], v[52:55], v[112:127]
    ds_read_b128 v[40:43], v13
    ds_read_b64_tr_b16 v[48:49], v18 offset:12288
    s_waitcnt lgkmcnt(5)
    v_mfma_f32_32x32x16_bf16 v[64:79], v[24:27], v[32:35], v[64:79]
    ds_read_b64_tr_b16 v[50:51], v18 offset:13312
    ds_read_b64_tr_b16 v[52:53], v19 offset:12288
    v_mfma_f32_4x4x4_16b_bf16 v[140:143], v[24:25], v[152:153], v[140:143]
    v_mfma_f32_4x4x4_16b_bf16 v[144:147], v[24:25], v[24:25], v[144:147]
    v_mfma_f32_4x4x4_16b_bf16 v[148:151], v[32:33], v[152:153], v[148:151]
    s_waitcnt lgkmcnt(5)
    v_mfma_f32_32x32x16_bf16 v[80:95], v[24:27], v[36:39], v[80:95]
    ds_read_b64_tr_b16 v[54:55], v19 offset:13312
    ds_read_b128 v[44:47], v17
    v_mfma_f32_4x4x4_16b_bf16 v[140:143], v[26:27], v[152:153], v[140:143]
    v_mfma_f32_4x4x4_16b_bf16 v[144:147], v[26:27], v[26:27], v[144:147]
    v_mfma_f32_4x4x4_16b_bf16 v[148:151], v[34:35], v[152:153], v[148:151]
    s_waitcnt lgkmcnt(6)
    v_mfma_f32_32x32x16_bf16 v[96:111], v[28:31], v[32:35], v[96:111]
    v_xor_b32 v12, s31, v12
    v_xor_b32 v16, s31, v16
    v_mfma_f32_32x32x16_bf16 v[112:127], v[28:31], v[36:39], v[112:127]
    s_waitcnt lgkmcnt(3)
    v_mfma_f32_32x32x16_bf16 v[64:79], v[40:43], v[48:51], v[64:79]
    v_xor_b32 v18, s31, v18
    v_xor_b32 v19, s31, v19
    v_mfma_f32_4x4x4_16b_bf16 v[140:143], v[40:41], v[152:153], v[140:143]
    v_mfma_f32_4x4x4_16b_bf16 v[144:147], v[40:41], v[40:41], v[144:147]
    v_mfma_f32_4x4x4_16b_bf16 v[148:151], v[48:49], v[152:153], v[148:151]
    s_waitcnt lgkmcnt(0)
    v_mfma_f32_32x32x16_bf16 v[80:95], v[40:43], v[52:55], v[80:95]
    s_barrier
    ds_read_b128 v[24:27], v10
    ds_read_b64_tr_b16 v[32:33], v18 offset:0
    ds_read_b64_tr_b16 v[34:35], v18 offset:1024
    v_mfma_f32_4x4x4_16b_bf16 v[140:143], v[42:43], v[152:153], v[140:143]
    v_mfma_f32_4x4x4_16b_bf16 v[144:147], v[42:43], v[42:43], v[144:147]
    v_mfma_f32_4x4x4_16b_bf16 v[148:151], v[50:51], v[152:153], v[148:151]
    v_mfma_f32_32x32x16_bf16 v[96:111], v[44:47], v[48:51], v[96:111]
    ds_read_b64_tr_b16 v[36:37], v19 offset:0
    ds_read_b64_tr_b16 v[38:39], v19 offset:1024
    ds_read_b128 v[28:31], v14
    v_xor_b32 v13, s31, v13
    v_xor_b32 v17, s31, v17
    v_mfma_f32_32x32x16_bf16 v[112:127], v[44:47], v[52:55], v[112:127]
    s_xor_b32 s31, s31, 0x18000
    s_add_u32 s29, s29, 1
    s_cmp_lt_u32 s29, 10
    s_cbranch_scc1 L_k1_loopV
    s_mov_b32 s46, 0x22222222
    s_mov_b32 s47, 0x22222222
    s_mov_b32 s48, 0x44444444
    s_mov_b32 s49, 0x44444444
    s_mov_b32 s50, 0x88888888
    s_mov_b32 s51, 0x88888888
    v_cndmask_b32 v20, v140, v141, s[46:47]
    v_cndmask_b32 v21, v144, v145, s[46:47]
    v_cndmask_b32 v22, v148, v149, s[46:47]
    v_cndmask_b32 v20, v20, v142, s[48:49]
    v_cndmask_b32 v21, v21, v146, s[48:49]
    v_cndmask_b32 v22, v22, v150, s[48:49]
    v_cndmask_b32 v20, v20, v143, s[50:51]
    v_cndmask_b32 v21, v21, v147, s[50:51]
    v_cndmask_b32 v22, v22, v151, s[50:51]
    v_mov_b32 v60, v20
    v_mov_b32 v61, v21
    v_mov_b32 v62, v22
    v_permlane32_swap_b32 v60, v20
    v_permlane32_swap_b32 v61, v21
    v_permlane32_swap_b32 v62, v22
    v_add_f32 v20, v20, v60
    v_add_f32 v21, v21, v61
    v_add_f32 v22, v22, v62
    v_mul_f32 v20, 0xbacccccd, v20
    v_mul_f32 v21, 0x3acccccd, v21
    v_fma_f32 v21, -v20, v20, v21
    v_max_f32 v21, 0, v21
    v_add_f32 v21, 0x3727c5ac, v21
    v_rsq_f32 v21, v21
    v_add_u32 v60, s39, v2
    v_add_u32 v61, s40, v2
    v_add_u32 v60, 131072, v60
    v_add_u32 v61, 132096, v61
    s_cmp_lt_u32 s26, 5
    s_cselect_b32 s33, 0x3ea52b5c, 1.0
    v_mul_f32 v21, s33, v21
    ds_write_b32 v60, v21
    ds_write_b32 v60, v20 offset:512
    ds_write_b32 v61, v22
    v_xor_b32 v6, 128, v4
    v_xor_b32 v7, 128, v5
    s_waitcnt lgkmcnt(0)
    s_barrier
    ds_read_b32 v130, v4
    ds_read_b32 v132, v6
    ds_read_b128 v[24:27], v5 offset:0
    ds_read_b128 v[40:43], v5 offset:512
    ds_read_b128 v[28:31], v5 offset:32
    ds_read_b128 v[44:47], v5 offset:544
    ds_read_b128 v[32:35], v5 offset:64
    ds_read_b128 v[48:51], v5 offset:576
    ds_read_b128 v[36:39], v5 offset:96
    ds_read_b128 v[52:55], v5 offset:608
    ds_read_b128 v[136:139], v7 offset:0
    ds_read_b128 v[152:155], v7 offset:512
    ds_read_b128 v[140:143], v7 offset:32
    ds_read_b128 v[156:159], v7 offset:544
    ds_read_b128 v[144:147], v7 offset:64
    ds_read_b128 v[160:163], v7 offset:576
    ds_read_b128 v[148:151], v7 offset:96
    ds_read_b128 v[164:167], v7 offset:608
    s_waitcnt lgkmcnt(8)
    v_pk_fma_f32 v[64:65], v[40:41], v[130:131], v[64:65] op_sel:[0,0,0] op_sel_hi:[1,0,1]
    v_pk_fma_f32 v[66:67], v[42:43], v[130:131], v[66:67] op_sel:[0,0,0] op_sel_hi:[1,0,1]
    v_pk_fma_f32 v[68:69], v[44:45], v[130:131], v[68:69] op_sel:[0,0,0] op_sel_hi:[1,0,1]
    v_pk_fma_f32 v[70:71], v[46:47], v[130:131], v[70:71] op_sel:[0,0,0] op_sel_hi:[1,0,1]
    v_pk_mul_f32 v[64:65], v[64:65], v[24:25]
    v_pk_mul_f32 v[66:67], v[66:67], v[26:27]
    v_pk_mul_f32 v[68:69], v[68:69], v[28:29]
    v_pk_mul_f32 v[70:71], v[70:71], v[30:31]
    v_cvt_pk_bf16_f32 v64, v64, v65
    v_cvt_pk_bf16_f32 v65, v66, v67
    v_cvt_pk_bf16_f32 v66, v68, v69
    v_cvt_pk_bf16_f32 v67, v70, v71
    buffer_store_dwordx4 v[64:67], v128, s[20:23], s42 offen offset:0
    v_pk_fma_f32 v[72:73], v[48:49], v[130:131], v[72:73] op_sel:[0,0,0] op_sel_hi:[1,0,1]
    v_pk_fma_f32 v[74:75], v[50:51], v[130:131], v[74:75] op_sel:[0,0,0] op_sel_hi:[1,0,1]
    v_pk_fma_f32 v[76:77], v[52:53], v[130:131], v[76:77] op_sel:[0,0,0] op_sel_hi:[1,0,1]
    v_pk_fma_f32 v[78:79], v[54:55], v[130:131], v[78:79] op_sel:[0,0,0] op_sel_hi:[1,0,1]
    v_pk_mul_f32 v[72:73], v[72:73], v[32:33]
    v_pk_mul_f32 v[74:75], v[74:75], v[34:35]
    v_pk_mul_f32 v[76:77], v[76:77], v[36:37]
    v_pk_mul_f32 v[78:79], v[78:79], v[38:39]
    v_cvt_pk_bf16_f32 v72, v72, v73
    v_cvt_pk_bf16_f32 v73, v74, v75
    v_cvt_pk_bf16_f32 v74, v76, v77
    v_cvt_pk_bf16_f32 v75, v78, v79
    buffer_store_dwordx4 v[72:75], v128, s[20:23], s42 offen offset:640
    v_pk_fma_f32 v[80:81], v[40:41], v[132:133], v[80:81] op_sel:[0,0,0] op_sel_hi:[1,0,1]
    v_pk_fma_f32 v[82:83], v[42:43], v[132:133], v[82:83] op_sel:[0,0,0] op_sel_hi:[1,0,1]
    v_pk_fma_f32 v[84:85], v[44:45], v[132:133], v[84:85] op_sel:[0,0,0] op_sel_hi:[1,0,1]
    v_pk_fma_f32 v[86:87], v[46:47], v[132:133], v[86:87] op_sel:[0,0,0] op_sel_hi:[1,0,1]
    v_pk_mul_f32 v[80:81], v[80:81], v[24:25]
    v_pk_mul_f32 v[82:83], v[82:83], v[26:27]
    v_pk_mul_f32 v[84:85], v[84:85], v[28:29]
    v_pk_mul_f32 v[86:87], v[86:87], v[30:31]
    v_cvt_pk_bf16_f32 v80, v80, v81
    v_cvt_pk_bf16_f32 v81, v82, v83
    v_cvt_pk_bf16_f32 v82, v84, v85
    v_cvt_pk_bf16_f32 v83, v86, v87
    buffer_store_dwordx4 v[80:83], v129, s[20:23], s42 offen offset:0
    v_pk_fma_f32 v[88:89], v[48:49], v[132:133], v[88:89] op_sel:[0,0,0] op_sel_hi:[1,0,1]
    v_pk_fma_f32 v[90:91], v[50:51], v[132:133], v[90:91] op_sel:[0,0,0] op_sel_hi:[1,0,1]
    v_pk_fma_f32 v[92:93], v[52:53], v[132:133], v[92:93] op_sel:[0,0,0] op_sel_hi:[1,0,1]
    v_pk_fma_f32 v[94:95], v[54:55], v[132:133], v[94:95] op_sel:[0,0,0] op_sel_hi:[1,0,1]
    v_pk_mul_f32 v[88:89], v[88:89], v[32:33]
    v_pk_mul_f32 v[90:91], v[90:91], v[34:35]
    v_pk_mul_f32 v[92:93], v[92:93], v[36:37]
    v_pk_mul_f32 v[94:95], v[94:95], v[38:39]
    v_cvt_pk_bf16_f32 v88, v88, v89
    v_cvt_pk_bf16_f32 v89, v90, v91
    v_cvt_pk_bf16_f32 v90, v92, v93
    v_cvt_pk_bf16_f32 v91, v94, v95
    buffer_store_dwordx4 v[88:91], v129, s[20:23], s42 offen offset:640
    s_waitcnt lgkmcnt(0)
    v_pk_fma_f32 v[96:97], v[152:153], v[130:131], v[96:97] op_sel:[0,0,0] op_sel_hi:[1,0,1]
    v_pk_fma_f32 v[98:99], v[154:155], v[130:131], v[98:99] op_sel:[0,0,0] op_sel_hi:[1,0,1]
    v_pk_fma_f32 v[100:101], v[156:157], v[130:131], v[100:101] op_sel:[0,0,0] op_sel_hi:[1,0,1]
    v_pk_fma_f32 v[102:103], v[158:159], v[130:131], v[102:103] op_sel:[0,0,0] op_sel_hi:[1,0,1]
    v_pk_mul_f32 v[96:97], v[96:97], v[136:137]
    v_pk_mul_f32 v[98:99], v[98:99], v[138:139]
    v_pk_mul_f32 v[100:101], v[100:101], v[140:141]
    v_pk_mul_f32 v[102:103], v[102:103], v[142:143]
    v_cvt_pk_bf16_f32 v96, v96, v97
    v_cvt_pk_bf16_f32 v97, v98, v99
    v_cvt_pk_bf16_f32 v98, v100, v101
    v_cvt_pk_bf16_f32 v99, v102, v103
    buffer_store_dwordx4 v[96:99], v128, s[20:23], s43 offen offset:0
    v_pk_fma_f32 v[104:105], v[160:161], v[130:131], v[104:105] op_sel:[0,0,0] op_sel_hi:[1,0,1]
    v_pk_fma_f32 v[106:107], v[162:163], v[130:131], v[106:107] op_sel:[0,0,0] op_sel_hi:[1,0,1]
    v_pk_fma_f32 v[108:109], v[164:165], v[130:131], v[108:109] op_sel:[0,0,0] op_sel_hi:[1,0,1]
    v_pk_fma_f32 v[110:111], v[166:167], v[130:131], v[110:111] op_sel:[0,0,0] op_sel_hi:[1,0,1]
    v_pk_mul_f32 v[104:105], v[104:105], v[144:145]
    v_pk_mul_f32 v[106:107], v[106:107], v[146:147]
    v_pk_mul_f32 v[108:109], v[108:109], v[148:149]
    v_pk_mul_f32 v[110:111], v[110:111], v[150:151]
    v_cvt_pk_bf16_f32 v104, v104, v105
    v_cvt_pk_bf16_f32 v105, v106, v107
    v_cvt_pk_bf16_f32 v106, v108, v109
    v_cvt_pk_bf16_f32 v107, v110, v111
    buffer_store_dwordx4 v[104:107], v128, s[20:23], s43 offen offset:640
    v_pk_fma_f32 v[112:113], v[152:153], v[132:133], v[112:113] op_sel:[0,0,0] op_sel_hi:[1,0,1]
    v_pk_fma_f32 v[114:115], v[154:155], v[132:133], v[114:115] op_sel:[0,0,0] op_sel_hi:[1,0,1]
    v_pk_fma_f32 v[116:117], v[156:157], v[132:133], v[116:117] op_sel:[0,0,0] op_sel_hi:[1,0,1]
    v_pk_fma_f32 v[118:119], v[158:159], v[132:133], v[118:119] op_sel:[0,0,0] op_sel_hi:[1,0,1]
    v_pk_mul_f32 v[112:113], v[112:113], v[136:137]
    v_pk_mul_f32 v[114:115], v[114:115], v[138:139]
    v_pk_mul_f32 v[116:117], v[116:117], v[140:141]
    v_pk_mul_f32 v[118:119], v[118:119], v[142:143]
    v_cvt_pk_bf16_f32 v112, v112, v113
    v_cvt_pk_bf16_f32 v113, v114, v115
    v_cvt_pk_bf16_f32 v114, v116, v117
    v_cvt_pk_bf16_f32 v115, v118, v119
    buffer_store_dwordx4 v[112:115], v129, s[20:23], s43 offen offset:0
    v_pk_fma_f32 v[120:121], v[160:161], v[132:133], v[120:121] op_sel:[0,0,0] op_sel_hi:[1,0,1]
    v_pk_fma_f32 v[122:123], v[162:163], v[132:133], v[122:123] op_sel:[0,0,0] op_sel_hi:[1,0,1]
    v_pk_fma_f32 v[124:125], v[164:165], v[132:133], v[124:125] op_sel:[0,0,0] op_sel_hi:[1,0,1]
    v_pk_fma_f32 v[126:127], v[166:167], v[132:133], v[126:127] op_sel:[0,0,0] op_sel_hi:[1,0,1]
    v_pk_mul_f32 v[120:121], v[120:121], v[144:145]
    v_pk_mul_f32 v[122:123], v[122:123], v[146:147]
    v_pk_mul_f32 v[124:125], v[124:125], v[148:149]
    v_pk_mul_f32 v[126:127], v[126:127], v[150:151]
    v_cvt_pk_bf16_f32 v120, v120, v121
    v_cvt_pk_bf16_f32 v121, v122, v123
    v_cvt_pk_bf16_f32 v122, v124, v125
    v_cvt_pk_bf16_f32 v123, v126, v127
    buffer_store_dwordx4 v[120:123], v129, s[20:23], s43 offen offset:640
L_k1_end:
    s_endpgm
k1_kernel_hotend:
L_k1_side:
    s_cmp_ge_u32 s2, 256
    s_cbranch_scc1 L_k1_end
    s_load_dwordx4 s[40:43], s[0:1], 32
    v_lshrrev_b32 v2, 6, v0
    v_and_b32 v1, 63, v0
    s_sub_u32 s25, s2, 240
    v_readfirstlane_b32 s24, v2
    v_lshlrev_b32 v2, 4, v1
    s_mov_b32 s14, 2211840
    s_mov_b32 s15, 0x20000
    s_mov_b32 s22, 30785536
    s_mov_b32 s23, 0x20000
    s_mul_i32 s27, s25, 40
    s_and_b32 s28, s24, 3
    s_mul_i32 s29, s28, 10
    s_add_u32 s27, s27, s29
    s_mul_i32 s27, s27, 3456
    s_cmp_lt_u32 s24, 4
    s_mov_b32 exec_hi, 0x003fffff
    s_waitcnt lgkmcnt(0)
    s_cselect_b32 s12, s40, s42
    s_cselect_b32 s13, s41, s43
    s_mov_b32 s20, s8
    s_mov_b32 s21, s9
    buffer_load_dwordx4 v[48:51], v2, s[12:15], s27 offen offset:0
    buffer_load_dwordx4 v[52:55], v2, s[12:15], s27 offen offset:864
    buffer_load_dwordx4 v[56:59], v2, s[12:15], s27 offen offset:1728
    buffer_load_dwordx4 v[60:63], v2, s[12:15], s27 offen offset:2592
    s_add_u32 s27, s27, 3456
    buffer_load_dwordx4 v[64:67], v2, s[12:15], s27 offen offset:0
    buffer_load_dwordx4 v[68:71], v2, s[12:15], s27 offen offset:864
    buffer_load_dwordx4 v[72:75], v2, s[12:15], s27 offen offset:1728
    buffer_load_dwordx4 v[76:79], v2, s[12:15], s27 offen offset:2592
    s_add_u32 s27, s27, 3456
    buffer_load_dwordx4 v[80:83], v2, s[12:15], s27 offen offset:0
    buffer_load_dwordx4 v[84:87], v2, s[12:15], s27 offen offset:864
    buffer_load_dwordx4 v[88:91], v2, s[12:15], s27 offen offset:1728
    buffer_load_dwordx4 v[92:95], v2, s[12:15], s27 offen offset:2592
    s_add_u32 s27, s27, 3456
    buffer_load_dwordx4 v[96:99], v2, s[12:15], s27 offen offset:0
    buffer_load_dwordx4 v[100:103], v2, s[12:15], s27 offen offset:864
    buffer_load_dwordx4 v[104:107], v2, s[12:15], s27 offen offset:1728
    buffer_load_dwordx4 v[108:111], v2, s[12:15], s27 offen offset:2592
    s_add_u32 s27, s27, 3456
    buffer_load_dwordx4 v[112:115], v2, s[12:15], s27 offen offset:0
    buffer_load_dwordx4 v[116:119], v2, s[12:15], s27 offen offset:864
    buffer_load_dwordx4 v[120:123], v2, s[12:15], s27 offen offset:1728
    buffer_load_dwordx4 v[124:127], v2, s[12:15], s27 offen offset:2592
    s_add_u32 s27, s27, 3456
    buffer_load_dwordx4 v[128:131], v2, s[12:15], s27 offen offset:0
    buffer_load_dwordx4 v[132:135], v2, s[12:15], s27 offen offset:864
    buffer_load_dwordx4 v[136:139], v2, s[12:15], s27 offen offset:1728
    buffer_load_dwordx4 v[140:143], v2, s[12:15], s27 offen offset:2592
    s_add_u32 s27, s27, 3456
    buffer_load_dwordx4 v[144:147], v2, s[12:15], s27 offen offset:0
    buffer_load_dwordx4 v[148:151], v2, s[12:15], s27 offen offset:864
    buffer_load_dwordx4 v[152:155], v2, s[12:15], s27 offen offset:1728
    buffer_load_dwordx4 v[156:159], v2, s[12:15], s27 offen offset:2592
    s_add_u32 s27, s27, 3456
    v_mov_b32 v8, 0
    v_mov_b32 v9, 0
    v_mov_b32 v10, 0
    v_mov_b32 v11, 0
    v_mov_b32 v12, 0
    v_mov_b32 v13, 0
    v_mov_b32 v14, 0
    v_mov_b32 v15, 0
    v_mov_b32 v16, 0
    v_mov_b32 v17, 0
    v_mov_b32 v18, 0
    v_mov_b32 v19, 0
    v_mov_b32 v20, 0
    v_mov_b32 v21, 0
    v_mov_b32 v22, 0
    v_mov_b32 v23, 0
    v_mov_b32 v24, 0
    v_mov_b32 v25, 0
    v_mov_b32 v26, 0
    v_mov_b32 v27, 0
    v_mov_b32 v28, 0
    v_mov_b32 v29, 0
    v_mov_b32 v30, 0
    v_mov_b32 v31, 0
    v_mov_b32 v32, 0
    v_mov_b32 v33, 0
    v_mov_b32 v34, 0
    v_mov_b32 v35, 0
    v_mov_b32 v36, 0
    v_mov_b32 v37, 0
    v_mov_b32 v38, 0
    v_mov_b32 v39, 0
    s_waitcnt vmcnt(24)
    v_lshlrev_b32 v4, 16, v48
    v_and_b32 v5, 0xffff0000, v48
    v_pk_add_f32 v[8:9], v[8:9], v[4:5]
    v_lshlrev_b32 v4, 16, v49
    v_and_b32 v5, 0xffff0000, v49
    v_pk_add_f32 v[10:11], v[10:11], v[4:5]
    v_lshlrev_b32 v4, 16, v50
    v_and_b32 v5, 0xffff0000, v50
    v_pk_add_f32 v[12:13], v[12:13], v[4:5]
    v_lshlrev_b32 v4, 16, v51
    v_and_b32 v5, 0xffff0000, v51
    v_pk_add_f32 v[14:15], v[14:15], v[4:5]
    v_lshlrev_b32 v4, 16, v52
    v_and_b32 v5, 0xffff0000, v52
    v_pk_add_f32 v[16:17], v[16:17], v[4:5]
    v_lshlrev_b32 v4, 16, v53
    v_and_b32 v5, 0xffff0000, v53
    v_pk_add_f32 v[18:19], v[18:19], v[4:5]
    v_lshlrev_b32 v4, 16, v54
    v_and_b32 v5, 0xffff0000, v54
    v_pk_add_f32 v[20:21], v[20:21], v[4:5]
    v_lshlrev_b32 v4, 16, v55
    v_and_b32 v5, 0xffff0000, v55
    v_pk_add_f32 v[22:23], v[22:23], v[4:5]
    v_lshlrev_b32 v4, 16, v56
    v_and_b32 v5, 0xffff0000, v56
    v_pk_add_f32 v[24:25], v[24:25], v[4:5]
    v_lshlrev_b32 v4, 16, v57
    v_and_b32 v5, 0xffff0000, v57
    v_pk_add_f32 v[26:27], v[26:27], v[4:5]
    v_lshlrev_b32 v4, 16, v58
    v_and_b32 v5, 0xffff0000, v58
    v_pk_add_f32 v[28:29], v[28:29], v[4:5]
    v_lshlrev_b32 v4, 16, v59
    v_and_b32 v5, 0xffff0000, v59
    v_pk_add_f32 v[30:31], v[30:31], v[4:5]
    v_lshlrev_b32 v4, 16, v60
    v_and_b32 v5, 0xffff0000, v60
    v_pk_add_f32 v[32:33], v[32:33], v[4:5]
    v_lshlrev_b32 v4, 16, v61
    v_and_b32 v5, 0xffff0000, v61
    v_pk_add_f32 v[34:35], v[34:35], v[4:5]
    v_lshlrev_b32 v4, 16, v62
    v_and_b32 v5, 0xffff0000, v62
    v_pk_add_f32 v[36:37], v[36:37], v[4:5]
    v_lshlrev_b32 v4, 16, v63
    v_and_b32 v5, 0xffff0000, v63
    v_pk_add_f32 v[38:39], v[38:39], v[4:5]
    buffer_load_dwordx4 v[48:51], v2, s[12:15], s27 offen offset:0
    buffer_load_dwordx4 v[52:55], v2, s[12:15], s27 offen offset:864
    buffer_load_dwordx4 v[56:59], v2, s[12:15], s27 offen offset:1728
    buffer_load_dwordx4 v[60:63], v2, s[12:15], s27 offen offset:2592
    s_add_u32 s27, s27, 3456
    s_waitcnt vmcnt(24)
    v_lshlrev_b32 v4, 16, v64
    v_and_b32 v5, 0xffff0000, v64
    v_pk_add_f32 v[8:9], v[8:9], v[4:5]
    v_lshlrev_b32 v4, 16, v65
    v_and_b32 v5, 0xffff0000, v65
    v_pk_add_f32 v[10:11], v[10:11], v[4:5]
    v_lshlrev_b32 v4, 16, v66
    v_and_b32 v5, 0xffff0000, v66
    v_pk_add_f32 v[12:13], v[12:13], v[4:5]
    v_lshlrev_b32 v4, 16, v67
    v_and_b32 v5, 0xffff0000, v67
    v_pk_add_f32 v[14:15], v[14:15], v[4:5]
    v_lshlrev_b32 v4, 16, v68
    v_and_b32 v5, 0xffff0000, v68
    v_pk_add_f32 v[16:17], v[16:17], v[4:5]
    v_lshlrev_b32 v4, 16, v69
    v_and_b32 v5, 0xffff0000, v69
    v_pk_add_f32 v[18:19], v[18:19], v[4:5]
    v_lshlrev_b32 v4, 16, v70
    v_and_b32 v5, 0xffff0000, v70
    v_pk_add_f32 v[20:21], v[20:21], v[4:5]
    v_lshlrev_b32 v4, 16, v71
    v_and_b32 v5, 0xffff0000, v71
    v_pk_add_f32 v[22:23], v[22:23], v[4:5]
    v_lshlrev_b32 v4, 16, v72
    v_and_b32 v5, 0xffff0000, v72
    v_pk_add_f32 v[24:25], v[24:25], v[4:5]
    v_lshlrev_b32 v4, 16, v73
    v_and_b32 v5, 0xffff0000, v73
    v_pk_add_f32 v[26:27], v[26:27], v[4:5]
    v_lshlrev_b32 v4, 16, v74
    v_and_b32 v5, 0xffff0000, v74
    v_pk_add_f32 v[28:29], v[28:29], v[4:5]
    v_lshlrev_b32 v4, 16, v75
    v_and_b32 v5, 0xffff0000, v75
    v_pk_add_f32 v[30:31], v[30:31], v[4:5]
    v_lshlrev_b32 v4, 16, v76
    v_and_b32 v5, 0xffff0000, v76
    v_pk_add_f32 v[32:33], v[32:33], v[4:5]
    v_lshlrev_b32 v4, 16, v77
    v_and_b32 v5, 0xffff0000, v77
    v_pk_add_f32 v[34:35], v[34:35], v[4:5]
    v_lshlrev_b32 v4, 16, v78
    v_and_b32 v5, 0xffff0000, v78
    v_pk_add_f32 v[36:37], v[36:37], v[4:5]
    v_lshlrev_b32 v4, 16, v79
    v_and_b32 v5, 0xffff0000, v79
    v_pk_add_f32 v[38:39], v[38:39], v[4:5]
    buffer_load_dwordx4 v[64:67], v2, s[12:15], s27 offen offset:0
    buffer_load_dwordx4 v[68:71], v2, s[12:15], s27 offen offset:864
    buffer_load_dwordx4 v[72:75], v2, s[12:15], s27 offen offset:1728
    buffer_load_dwordx4 v[76:79], v2, s[12:15], s27 offen offset:2592
    s_add_u32 s27, s27, 3456
    s_waitcnt vmcnt(24)
    v_lshlrev_b32 v4, 16, v80
    v_and_b32 v5, 0xffff0000, v80
    v_pk_add_f32 v[8:9], v[8:9], v[4:5]
    v_lshlrev_b32 v4, 16, v81
    v_and_b32 v5, 0xffff0000, v81
    v_pk_add_f32 v[10:11], v[10:11], v[4:5]
    v_lshlrev_b32 v4, 16, v82
    v_and_b32 v5, 0xffff0000, v82
    v_pk_add_f32 v[12:13], v[12:13], v[4:5]
    v_lshlrev_b32 v4, 16, v83
    v_and_b32 v5, 0xffff0000, v83
    v_pk_add_f32 v[14:15], v[14:15], v[4:5]
    v_lshlrev_b32 v4, 16, v84
    v_and_b32 v5, 0xffff0000, v84
    v_pk_add_f32 v[16:17], v[16:17], v[4:5]
    v_lshlrev_b32 v4, 16, v85
    v_and_b32 v5, 0xffff0000, v85
    v_pk_add_f32 v[18:19], v[18:19], v[4:5]
    v_lshlrev_b32 v4, 16, v86
    v_and_b32 v5, 0xffff0000, v86
    v_pk_add_f32 v[20:21], v[20:21], v[4:5]
    v_lshlrev_b32 v4, 16, v87
    v_and_b32 v5, 0xffff0000, v87
    v_pk_add_f32 v[22:23], v[22:23], v[4:5]
    v_lshlrev_b32 v4, 16, v88
    v_and_b32 v5, 0xffff0000, v88
    v_pk_add_f32 v[24:25], v[24:25], v[4:5]
    v_lshlrev_b32 v4, 16, v89
    v_and_b32 v5, 0xffff0000, v89
    v_pk_add_f32 v[26:27], v[26:27], v[4:5]
    v_lshlrev_b32 v4, 16, v90
    v_and_b32 v5, 0xffff0000, v90
    v_pk_add_f32 v[28:29], v[28:29], v[4:5]
    v_lshlrev_b32 v4, 16, v91
    v_and_b32 v5, 0xffff0000, v91
    v_pk_add_f32 v[30:31], v[30:31], v[4:5]
    v_lshlrev_b32 v4, 16, v92
    v_and_b32 v5, 0xffff0000, v92
    v_pk_add_f32 v[32:33], v[32:33], v[4:5]
    v_lshlrev_b32 v4, 16, v93
    v_and_b32 v5, 0xffff0000, v93
    v_pk_add_f32 v[34:35], v[34:35], v[4:5]
    v_lshlrev_b32 v4, 16, v94
    v_and_b32 v5, 0xffff0000, v94
    v_pk_add_f32 v[36:37], v[36:37], v[4:5]
    v_lshlrev_b32 v4, 16, v95
    v_and_b32 v5, 0xffff0000, v95
    v_pk_add_f32 v[38:39], v[38:39], v[4:5]
    buffer_load_dwordx4 v[80:83], v2, s[12:15], s27 offen offset:0
    buffer_load_dwordx4 v[84:87], v2, s[12:15], s27 offen offset:864
    buffer_load_dwordx4 v[88:91], v2, s[12:15], s27 offen offset:1728
    buffer_load_dwordx4 v[92:95], v2, s[12:15], s27 offen offset:2592
    s_add_u32 s27, s27, 3456
    s_waitcnt vmcnt(24)
    v_lshlrev_b32 v4, 16, v96
    v_and_b32 v5, 0xffff0000, v96
    v_pk_add_f32 v[8:9], v[8:9], v[4:5]
    v_lshlrev_b32 v4, 16, v97
    v_and_b32 v5, 0xffff0000, v97
    v_pk_add_f32 v[10:11], v[10:11], v[4:5]
    v_lshlrev_b32 v4, 16, v98
    v_and_b32 v5, 0xffff0000, v98
    v_pk_add_f32 v[12:13], v[12:13], v[4:5]
    v_lshlrev_b32 v4, 16, v99
    v_and_b32 v5, 0xffff0000, v99
    v_pk_add_f32 v[14:15], v[14:15], v[4:5]
    v_lshlrev_b32 v4, 16, v100
    v_and_b32 v5, 0xffff0000, v100
    v_pk_add_f32 v[16:17], v[16:17], v[4:5]
    v_lshlrev_b32 v4, 16, v101
    v_and_b32 v5, 0xffff0000, v101
    v_pk_add_f32 v[18:19], v[18:19], v[4:5]
    v_lshlrev_b32 v4, 16, v102
    v_and_b32 v5, 0xffff0000, v102
    v_pk_add_f32 v[20:21], v[20:21], v[4:5]
    v_lshlrev_b32 v4, 16, v103
    v_and_b32 v5, 0xffff0000, v103
    v_pk_add_f32 v[22:23], v[22:23], v[4:5]
    v_lshlrev_b32 v4, 16, v104
    v_and_b32 v5, 0xffff0000, v104
    v_pk_add_f32 v[24:25], v[24:25], v[4:5]
    v_lshlrev_b32 v4, 16, v105
    v_and_b32 v5, 0xffff0000, v105
    v_pk_add_f32 v[26:27], v[26:27], v[4:5]
    v_lshlrev_b32 v4, 16, v106
    v_and_b32 v5, 0xffff0000, v106
    v_pk_add_f32 v[28:29], v[28:29], v[4:5]
    v_lshlrev_b32 v4, 16, v107
    v_and_b32 v5, 0xffff0000, v107
    v_pk_add_f32 v[30:31], v[30:31], v[4:5]
    v_lshlrev_b32 v4, 16, v108
    v_and_b32 v5, 0xffff0000, v108
    v_pk_add_f32 v[32:33], v[32:33], v[4:5]
    v_lshlrev_b32 v4, 16, v109
    v_and_b32 v5, 0xffff0000, v109
    v_pk_add_f32 v[34:35], v[34:35], v[4:5]
    v_lshlrev_b32 v4, 16, v110
    v_and_b32 v5, 0xffff0000, v110
    v_pk_add_f32 v[36:37], v[36:37], v[4:5]
    v_lshlrev_b32 v4, 16, v111
    v_and_b32 v5, 0xffff0000, v111
    v_pk_add_f32 v[38:39], v[38:39], v[4:5]
    s_waitcnt vmcnt(20)
    v_lshlrev_b32 v4, 16, v112
    v_and_b32 v5, 0xffff0000, v112
    v_pk_add_f32 v[8:9], v[8:9], v[4:5]
    v_lshlrev_b32 v4, 16, v113
    v_and_b32 v5, 0xffff0000, v113
    v_pk_add_f32 v[10:11], v[10:11], v[4:5]
    v_lshlrev_b32 v4, 16, v114
    v_and_b32 v5, 0xffff0000, v114
    v_pk_add_f32 v[12:13], v[12:13], v[4:5]
    v_lshlrev_b32 v4, 16, v115
    v_and_b32 v5, 0xffff0000, v115
    v_pk_add_f32 v[14:15], v[14:15], v[4:5]
    v_lshlrev_b32 v4, 16, v116
    v_and_b32 v5, 0xffff0000, v116
    v_pk_add_f32 v[16:17], v[16:17], v[4:5]
    v_lshlrev_b32 v4, 16, v117
    v_and_b32 v5, 0xffff0000, v117
    v_pk_add_f32 v[18:19], v[18:19], v[4:5]
    v_lshlrev_b32 v4, 16, v118
    v_and_b32 v5, 0xffff0000, v118
    v_pk_add_f32 v[20:21], v[20:21], v[4:5]
    v_lshlrev_b32 v4, 16, v119
    v_and_b32 v5, 0xffff0000, v119
    v_pk_add_f32 v[22:23], v[22:23], v[4:5]
    v_lshlrev_b32 v4, 16, v120
    v_and_b32 v5, 0xffff0000, v120
    v_pk_add_f32 v[24:25], v[24:25], v[4:5]
    v_lshlrev_b32 v4, 16, v121
    v_and_b32 v5, 0xffff0000, v121
    v_pk_add_f32 v[26:27], v[26:27], v[4:5]
    v_lshlrev_b32 v4, 16, v122
    v_and_b32 v5, 0xffff0000, v122
    v_pk_add_f32 v[28:29], v[28:29], v[4:5]
    v_lshlrev_b32 v4, 16, v123
    v_and_b32 v5, 0xffff0000, v123
    v_pk_add_f32 v[30:31], v[30:31], v[4:5]
    v_lshlrev_b32 v4, 16, v124
    v_and_b32 v5, 0xffff0000, v124
    v_pk_add_f32 v[32:33], v[32:33], v[4:5]
    v_lshlrev_b32 v4, 16, v125
    v_and_b32 v5, 0xffff0000, v125
    v_pk_add_f32 v[34:35], v[34:35], v[4:5]
    v_lshlrev_b32 v4, 16, v126
    v_and_b32 v5, 0xffff0000, v126
    v_pk_add_f32 v[36:37], v[36:37], v[4:5]
    v_lshlrev_b32 v4, 16, v127
    v_and_b32 v5, 0xffff0000, v127
    v_pk_add_f32 v[38:39], v[38:39], v[4:5]
    s_waitcnt vmcnt(16)
    v_lshlrev_b32 v4, 16, v128
    v_and_b32 v5, 0xffff0000, v128
    v_pk_add_f32 v[8:9], v[8:9], v[4:5]
    v_lshlrev_b32 v4, 16, v129
    v_and_b32 v5, 0xffff0000, v129
    v_pk_add_f32 v[10:11], v[10:11], v[4:5]
    v_lshlrev_b32 v4, 16, v130
    v_and_b32 v5, 0xffff0000, v130
    v_pk_add_f32 v[12:13], v[12:13], v[4:5]
    v_lshlrev_b32 v4, 16, v131
    v_and_b32 v5, 0xffff0000, v131
    v_pk_add_f32 v[14:15], v[14:15], v[4:5]
    v_lshlrev_b32 v4, 16, v132
    v_and_b32 v5, 0xffff0000, v132
    v_pk_add_f32 v[16:17], v[16:17], v[4:5]
    v_lshlrev_b32 v4, 16, v133
    v_and_b32 v5, 0xffff0000, v133
    v_pk_add_f32 v[18:19], v[18:19], v[4:5]
    v_lshlrev_b32 v4, 16, v134
    v_and_b32 v5, 0xffff0000, v134
    v_pk_add_f32 v[20:21], v[20:21], v[4:5]
    v_lshlrev_b32 v4, 16, v135
    v_and_b32 v5, 0xffff0000, v135
    v_pk_add_f32 v[22:23], v[22:23], v[4:5]
    v_lshlrev_b32 v4, 16, v136
    v_and_b32 v5, 0xffff0000, v136
    v_pk_add_f32 v[24:25], v[24:25], v[4:5]
    v_lshlrev_b32 v4, 16, v137
    v_and_b32 v5, 0xffff0000, v137
    v_pk_add_f32 v[26:27], v[26:27], v[4:5]
    v_lshlrev_b32 v4, 16, v138
    v_and_b32 v5, 0xffff0000, v138
    v_pk_add_f32 v[28:29], v[28:29], v[4:5]
    v_lshlrev_b32 v4, 16, v139
    v_and_b32 v5, 0xffff0000, v139
    v_pk_add_f32 v[30:31], v[30:31], v[4:5]
    v_lshlrev_b32 v4, 16, v140
    v_and_b32 v5, 0xffff0000, v140
    v_pk_add_f32 v[32:33], v[32:33], v[4:5]
    v_lshlrev_b32 v4, 16, v141
    v_and_b32 v5, 0xffff0000, v141
    v_pk_add_f32 v[34:35], v[34:35], v[4:5]
    v_lshlrev_b32 v4, 16, v142
    v_and_b32 v5, 0xffff0000, v142
    v_pk_add_f32 v[36:37], v[36:37], v[4:5]
    v_lshlrev_b32 v4, 16, v143
    v_and_b32 v5, 0xffff0000, v143
    v_pk_add_f32 v[38:39], v[38:39], v[4:5]
    s_waitcnt vmcnt(12)
    v_lshlrev_b32 v4, 16, v144
    v_and_b32 v5, 0xffff0000, v144
    v_pk_add_f32 v[8:9], v[8:9], v[4:5]
    v_lshlrev_b32 v4, 16, v145
    v_and_b32 v5, 0xffff0000, v145
    v_pk_add_f32 v[10:11], v[10:11], v[4:5]
    v_lshlrev_b32 v4, 16, v146
    v_and_b32 v5, 0xffff0000, v146
    v_pk_add_f32 v[12:13], v[12:13], v[4:5]
    v_lshlrev_b32 v4, 16, v147
    v_and_b32 v5, 0xffff0000, v147
    v_pk_add_f32 v[14:15], v[14:15], v[4:5]
    v_lshlrev_b32 v4, 16, v148
    v_and_b32 v5, 0xffff0000, v148
    v_pk_add_f32 v[16:17], v[16:17], v[4:5]
    v_lshlrev_b32 v4, 16, v149
    v_and_b32 v5, 0xffff0000, v149
    v_pk_add_f32 v[18:19], v[18:19], v[4:5]
    v_lshlrev_b32 v4, 16, v150
    v_and_b32 v5, 0xffff0000, v150
    v_pk_add_f32 v[20:21], v[20:21], v[4:5]
    v_lshlrev_b32 v4, 16, v151
    v_and_b32 v5, 0xffff0000, v151
    v_pk_add_f32 v[22:23], v[22:23], v[4:5]
    v_lshlrev_b32 v4, 16, v152
    v_and_b32 v5, 0xffff0000, v152
    v_pk_add_f32 v[24:25], v[24:25], v[4:5]
    v_lshlrev_b32 v4, 16, v153
    v_and_b32 v5, 0xffff0000, v153
    v_pk_add_f32 v[26:27], v[26:27], v[4:5]
    v_lshlrev_b32 v4, 16, v154
    v_and_b32 v5, 0xffff0000, v154
    v_pk_add_f32 v[28:29], v[28:29], v[4:5]
    v_lshlrev_b32 v4, 16, v155
    v_and_b32 v5, 0xffff0000, v155
    v_pk_add_f32 v[30:31], v[30:31], v[4:5]
    v_lshlrev_b32 v4, 16, v156
    v_and_b32 v5, 0xffff0000, v156
    v_pk_add_f32 v[32:33], v[32:33], v[4:5]
    v_lshlrev_b32 v4, 16, v157
    v_and_b32 v5, 0xffff0000, v157
    v_pk_add_f32 v[34:35], v[34:35], v[4:5]
    v_lshlrev_b32 v4, 16, v158
    v_and_b32 v5, 0xffff0000, v158
    v_pk_add_f32 v[36:37], v[36:37], v[4:5]
    v_lshlrev_b32 v4, 16, v159
    v_and_b32 v5, 0xffff0000, v159
    v_pk_add_f32 v[38:39], v[38:39], v[4:5]
    s_waitcnt vmcnt(8)
    v_lshlrev_b32 v4, 16, v48
    v_and_b32 v5, 0xffff0000, v48
    v_pk_add_f32 v[8:9], v[8:9], v[4:5]
    v_lshlrev_b32 v4, 16, v49
    v_and_b32 v5, 0xffff0000, v49
    v_pk_add_f32 v[10:11], v[10:11], v[4:5]
    v_lshlrev_b32 v4, 16, v50
    v_and_b32 v5, 0xffff0000, v50
    v_pk_add_f32 v[12:13], v[12:13], v[4:5]
    v_lshlrev_b32 v4, 16, v51
    v_and_b32 v5, 0xffff0000, v51
    v_pk_add_f32 v[14:15], v[14:15], v[4:5]
    v_lshlrev_b32 v4, 16, v52
    v_and_b32 v5, 0xffff0000, v52
    v_pk_add_f32 v[16:17], v[16:17], v[4:5]
    v_lshlrev_b32 v4, 16, v53
    v_and_b32 v5, 0xffff0000, v53
    v_pk_add_f32 v[18:19], v[18:19], v[4:5]
    v_lshlrev_b32 v4, 16, v54
    v_and_b32 v5, 0xffff0000, v54
    v_pk_add_f32 v[20:21], v[20:21], v[4:5]
    v_lshlrev_b32 v4, 16, v55
    v_and_b32 v5, 0xffff0000, v55
    v_pk_add_f32 v[22:23], v[22:23], v[4:5]
    v_lshlrev_b32 v4, 16, v56
    v_and_b32 v5, 0xffff0000, v56
    v_pk_add_f32 v[24:25], v[24:25], v[4:5]
    v_lshlrev_b32 v4, 16, v57
    v_and_b32 v5, 0xffff0000, v57
    v_pk_add_f32 v[26:27], v[26:27], v[4:5]
    v_lshlrev_b32 v4, 16, v58
    v_and_b32 v5, 0xffff0000, v58
    v_pk_add_f32 v[28:29], v[28:29], v[4:5]
    v_lshlrev_b32 v4, 16, v59
    v_and_b32 v5, 0xffff0000, v59
    v_pk_add_f32 v[30:31], v[30:31], v[4:5]
    v_lshlrev_b32 v4, 16, v60
    v_and_b32 v5, 0xffff0000, v60
    v_pk_add_f32 v[32:33], v[32:33], v[4:5]
    v_lshlrev_b32 v4, 16, v61
    v_and_b32 v5, 0xffff0000, v61
    v_pk_add_f32 v[34:35], v[34:35], v[4:5]
    v_lshlrev_b32 v4, 16, v62
    v_and_b32 v5, 0xffff0000, v62
    v_pk_add_f32 v[36:37], v[36:37], v[4:5]
    v_lshlrev_b32 v4, 16, v63
    v_and_b32 v5, 0xffff0000, v63
    v_pk_add_f32 v[38:39], v[38:39], v[4:5]
    s_waitcnt vmcnt(4)
    v_lshlrev_b32 v4, 16, v64
    v_and_b32 v5, 0xffff0000, v64
    v_pk_add_f32 v[8:9], v[8:9], v[4:5]
    v_lshlrev_b32 v4, 16, v65
    v_and_b32 v5, 0xffff0000, v65
    v_pk_add_f32 v[10:11], v[10:11], v[4:5]
    v_lshlrev_b32 v4, 16, v66
    v_and_b32 v5, 0xffff0000, v66
    v_pk_add_f32 v[12:13], v[12:13], v[4:5]
    v_lshlrev_b32 v4, 16, v67
    v_and_b32 v5, 0xffff0000, v67
    v_pk_add_f32 v[14:15], v[14:15], v[4:5]
    v_lshlrev_b32 v4, 16, v68
    v_and_b32 v5, 0xffff0000, v68
    v_pk_add_f32 v[16:17], v[16:17], v[4:5]
    v_lshlrev_b32 v4, 16, v69
    v_and_b32 v5, 0xffff0000, v69
    v_pk_add_f32 v[18:19], v[18:19], v[4:5]
    v_lshlrev_b32 v4, 16, v70
    v_and_b32 v5, 0xffff0000, v70
    v_pk_add_f32 v[20:21], v[20:21], v[4:5]
    v_lshlrev_b32 v4, 16, v71
    v_and_b32 v5, 0xffff0000, v71
    v_pk_add_f32 v[22:23], v[22:23], v[4:5]
    v_lshlrev_b32 v4, 16, v72
    v_and_b32 v5, 0xffff0000, v72
    v_pk_add_f32 v[24:25], v[24:25], v[4:5]
    v_lshlrev_b32 v4, 16, v73
    v_and_b32 v5, 0xffff0000, v73
    v_pk_add_f32 v[26:27], v[26:27], v[4:5]
    v_lshlrev_b32 v4, 16, v74
    v_and_b32 v5, 0xffff0000, v74
    v_pk_add_f32 v[28:29], v[28:29], v[4:5]
    v_lshlrev_b32 v4, 16, v75
    v_and_b32 v5, 0xffff0000, v75
    v_pk_add_f32 v[30:31], v[30:31], v[4:5]
    v_lshlrev_b32 v4, 16, v76
    v_and_b32 v5, 0xffff0000, v76
    v_pk_add_f32 v[32:33], v[32:33], v[4:5]
    v_lshlrev_b32 v4, 16, v77
    v_and_b32 v5, 0xffff0000, v77
    v_pk_add_f32 v[34:35], v[34:35], v[4:5]
    v_lshlrev_b32 v4, 16, v78
    v_and_b32 v5, 0xffff0000, v78
    v_pk_add_f32 v[36:37], v[36:37], v[4:5]
    v_lshlrev_b32 v4, 16, v79
    v_and_b32 v5, 0xffff0000, v79
    v_pk_add_f32 v[38:39], v[38:39], v[4:5]
    s_waitcnt vmcnt(0)
    v_lshlrev_b32 v4, 16, v80
    v_and_b32 v5, 0xffff0000, v80
    v_pk_add_f32 v[8:9], v[8:9], v[4:5]
    v_lshlrev_b32 v4, 16, v81
    v_and_b32 v5, 0xffff0000, v81
    v_pk_add_f32 v[10:11], v[10:11], v[4:5]
    v_lshlrev_b32 v4, 16, v82
    v_and_b32 v5, 0xffff0000, v82
    v_pk_add_f32 v[12:13], v[12:13], v[4:5]
    v_lshlrev_b32 v4, 16, v83
    v_and_b32 v5, 0xffff0000, v83
    v_pk_add_f32 v[14:15], v[14:15], v[4:5]
    v_lshlrev_b32 v4, 16, v84
    v_and_b32 v5, 0xffff0000, v84
    v_pk_add_f32 v[16:17], v[16:17], v[4:5]
    v_lshlrev_b32 v4, 16, v85
    v_and_b32 v5, 0xffff0000, v85
    v_pk_add_f32 v[18:19], v[18:19], v[4:5]
    v_lshlrev_b32 v4, 16, v86
    v_and_b32 v5, 0xffff0000, v86
    v_pk_add_f32 v[20:21], v[20:21], v[4:5]
    v_lshlrev_b32 v4, 16, v87
    v_and_b32 v5, 0xffff0000, v87
    v_pk_add_f32 v[22:23], v[22:23], v[4:5]
    v_lshlrev_b32 v4, 16, v88
    v_and_b32 v5, 0xffff0000, v88
    v_pk_add_f32 v[24:25], v[24:25], v[4:5]
    v_lshlrev_b32 v4, 16, v89
    v_and_b32 v5, 0xffff0000, v89
    v_pk_add_f32 v[26:27], v[26:27], v[4:5]
    v_lshlrev_b32 v4, 16, v90
    v_and_b32 v5, 0xffff0000, v90
    v_pk_add_f32 v[28:29], v[28:29], v[4:5]
    v_lshlrev_b32 v4, 16, v91
    v_and_b32 v5, 0xffff0000, v91
    v_pk_add_f32 v[30:31], v[30:31], v[4:5]
    v_lshlrev_b32 v4, 16, v92
    v_and_b32 v5, 0xffff0000, v92
    v_pk_add_f32 v[32:33], v[32:33], v[4:5]
    v_lshlrev_b32 v4, 16, v93
    v_and_b32 v5, 0xffff0000, v93
    v_pk_add_f32 v[34:35], v[34:35], v[4:5]
    v_lshlrev_b32 v4, 16, v94
    v_and_b32 v5, 0xffff0000, v94
    v_pk_add_f32 v[36:37], v[36:37], v[4:5]
    v_lshlrev_b32 v4, 16, v95
    v_and_b32 v5, 0xffff0000, v95
    v_pk_add_f32 v[38:39], v[38:39], v[4:5]
    s_mul_i32 s29, s24, 6912
    v_lshl_add_u32 v3, v1, 5, s29
    ds_write_b128 v3, v[8:11] offset:0
    ds_write_b128 v3, v[12:15] offset:16
    ds_write_b128 v3, v[16:19] offset:1728
    ds_write_b128 v3, v[20:23] offset:1744
    ds_write_b128 v3, v[24:27] offset:3456
    ds_write_b128 v3, v[28:31] offset:3472
    ds_write_b128 v3, v[32:35] offset:5184
    ds_write_b128 v3, v[36:39] offset:5200
    s_lshr_b32 s29, s24, 2
    s_mul_i32 s30, s29, 27648
    s_mul_i32 s31, s28, 1728
    s_add_u32 s30, s30, s31
    v_lshl_add_u32 v3, v1, 5, s30
    s_mul_i32 s29, s29, 6912
    s_add_u32 s29, s29, s31
    s_mul_i32 s30, s25, 13824
    s_add_u32 s29, s29, s30
    s_add_u32 s29, s29, 30556160
    v_lshlrev_b32 v2, 5, v1
    s_waitcnt lgkmcnt(0)
    s_barrier
    ds_read_b128 v[8:11], v3 offset:0
    ds_read_b128 v[12:15], v3 offset:16
    ds_read_b128 v[16:19], v3 offset:6912
    ds_read_b128 v[20:23], v3 offset:6928
    ds_read_b128 v[24:27], v3 offset:13824
    ds_read_b128 v[28:31], v3 offset:13840
    ds_read_b128 v[32:35], v3 offset:20736
    ds_read_b128 v[36:39], v3 offset:20752
    s_waitcnt lgkmcnt(0)
    v_pk_add_f32 v[8:9], v[8:9], v[16:17]
    v_pk_add_f32 v[24:25], v[24:25], v[32:33]
    v_pk_add_f32 v[8:9], v[8:9], v[24:25]
    v_pk_add_f32 v[10:11], v[10:11], v[18:19]
    v_pk_add_f32 v[26:27], v[26:27], v[34:35]
    v_pk_add_f32 v[10:11], v[10:11], v[26:27]
    v_pk_add_f32 v[12:13], v[12:13], v[20:21]
    v_pk_add_f32 v[28:29], v[28:29], v[36:37]
    v_pk_add_f32 v[12:13], v[12:13], v[28:29]
    v_pk_add_f32 v[14:15], v[14:15], v[22:23]
    v_pk_add_f32 v[30:31], v[30:31], v[38:39]
    v_pk_add_f32 v[14:15], v[14:15], v[30:31]
    buffer_store_dwordx4 v[8:11], v2, s[20:23], s29 offen
    buffer_store_dwordx4 v[12:15], v2, s[20:23], s29 offen offset:16
    s_endpgm
k1_kernel_codeend:
.p2align 8
.globl k2_kernel
.type k2_kernel,@function
k2_kernel:
    s_load_dwordx2 s[8:9], s[0:1], 72
    s_load_dwordx2 s[40:41], s[0:1], 16
    s_load_dwordx4 s[44:47], s[0:1], 32
    s_load_dwordx2 s[42:43], s[0:1], 48
    s_cmp_ge_u32 s2, 256
    s_cbranch_scc1 L_k2_end
    v_lshrrev_b32 v2, 6, v0
    v_and_b32 v1, 63, v0
    s_and_b32 s10, s2, 7
    v_readfirstlane_b32 s24, v2
    s_lshl_b32 s10, s10, 2
    s_lshr_b32 s11, s2, 6
    s_add_u32 s25, s10, s11
    s_bfe_u32 s26, s2, 0x30003
    s_mul_i32 s27, s25, 163840
    v_lshlrev_b32 v136, 4, v1
    s_mov_b32 s14, 30785536
    s_mov_b32 s15, 0x20000
    s_cmp_lt_u32 s24, 8
    s_cbranch_scc1 L_k2_compute
    s_sub_u32 s24, s24, 8
    s_mul_i32 s28, s24, 81920
    s_add_u32 s27, s27, s28
    s_setprio 3
    s_waitcnt lgkmcnt(0)
    s_mov_b32 s12, s8
    s_mov_b32 s13, s9
    s_mov_b32 s29, 4
L_k2_l0:
    s_mov_b32 m0, s28
    s_add_u32 s28, s28, 4096
    buffer_load_dwordx4 v136, s[12:15], s27 offen offset:0 lds
    buffer_load_dwordx4 v136, s[12:15], s27 offen offset:1024 lds
    buffer_load_dwordx4 v136, s[12:15], s27 offen offset:2048 lds
    buffer_load_dwordx4 v136, s[12:15], s27 offen offset:3072 lds
    s_add_u32 s27, s27, 4096
    s_sub_u32 s29, s29, 1
    s_cmp_lg_u32 s29, 0
    s_cbranch_scc1 L_k2_l0
    s_waitcnt vmcnt(6)
    s_barrier
    s_mov_b32 s29, 7
L_k2_l1:
    s_mov_b32 m0, s28
    s_add_u32 s28, s28, 4096
    buffer_load_dwordx4 v136, s[12:15], s27 offen offset:0 lds
    buffer_load_dwordx4 v136, s[12:15], s27 offen offset:1024 lds
    buffer_load_dwordx4 v136, s[12:15], s27 offen offset:2048 lds
    buffer_load_dwordx4 v136, s[12:15], s27 offen offset:3072 lds
    s_add_u32 s27, s27, 4096
    s_sub_u32 s29, s29, 1
    s_cmp_lg_u32 s29, 0
    s_cbranch_scc1 L_k2_l1
    s_waitcnt vmcnt(12)
    s_barrier
    s_mov_b32 s29, 9
L_k2_l2:
    s_mov_b32 m0, s28
    s_add_u32 s28, s28, 4096
    buffer_load_dwordx4 v136, s[12:15], s27 offen offset:0 lds
    buffer_load_dwordx4 v136, s[12:15], s27 offen offset:1024 lds
    buffer_load_dwordx4 v136, s[12:15], s27 offen offset:2048 lds
    buffer_load_dwordx4 v136, s[12:15], s27 offen offset:3072 lds
    s_add_u32 s27, s27, 4096
    s_sub_u32 s29, s29, 1
    s_cmp_lg_u32 s29, 0
    s_cbranch_scc1 L_k2_l2
    s_waitcnt vmcnt(0)
    s_barrier
    s_and_b32 s28, s2, 0
    s_mul_i32 s28, s28, 409600
    s_lshr_b32 s29, s2, 3
    s_mul_i32 s30, s29, 25600
    s_add_u32 s28, s28, s30
    s_add_u32 s28, s28, 29736960
    s_bfe_u32 s30, s2, 0x20001
    s_mul_i32 s30, s30, 1146880
    s_mul_i32 s29, s29, 35840
    s_add_u32 s29, s29, s30
    s_add_u32 s29, s29, 22937600
    s_mul_i32 s30, s24, 13312
    s_add_u32 s28, s28, s30
    s_mul_i32 s30, s24, 18432
    s_add_u32 s29, s29, s30
    s_setprio 0
    s_barrier
    buffer_load_dwordx4 v[4:7], v136, s[12:15], s28 offen offset:0
    buffer_load_dwordx4 v[4:7], v136, s[12:15], s28 offen offset:1024
    buffer_load_dwordx4 v[4:7], v136, s[12:15], s28 offen offset:2048
    buffer_load_dwordx4 v[4:7], v136, s[12:15], s28 offen offset:3072
    s_add_u32 s28, s28, 4096
    buffer_load_dwordx4 v[4:7], v136, s[12:15], s28 offen offset:0
    buffer_load_dwordx4 v[4:7], v136, s[12:15], s28 offen offset:1024
    buffer_load_dwordx4 v[4:7], v136, s[12:15], s28 offen offset:2048
    buffer_load_dwordx4 v[4:7], v136, s[12:15], s28 offen offset:3072
    s_add_u32 s28, s28, 4096
    buffer_load_dwordx4 v[4:7], v136, s[12:15], s28 offen offset:0
    buffer_load_dwordx4 v[4:7], v136, s[12:15], s28 offen offset:1024
    buffer_load_dwordx4 v[4:7], v136, s[12:15], s28 offen offset:2048
    buffer_load_dwordx4 v[4:7], v136, s[12:15], s28 offen offset:3072
    s_add_u32 s28, s28, 4096
    buffer_load_dwordx4 v[4:7], v136, s[12:15], s28 offen offset:0
    buffer_load_dwordx4 v[4:7], v136, s[12:15], s29 offen offset:0
    buffer_load_dwordx4 v[4:7], v136, s[12:15], s29 offen offset:1024
    buffer_load_dwordx4 v[4:7], v136, s[12:15], s29 offen offset:2048
    buffer_load_dwordx4 v[4:7], v136, s[12:15], s29 offen offset:3072
    s_add_u32 s29, s29, 4096
    buffer_load_dwordx4 v[4:7], v136, s[12:15], s29 offen offset:0
    buffer_load_dwordx4 v[4:7], v136, s[12:15], s29 offen offset:1024
    buffer_load_dwordx4 v[4:7], v136, s[12:15], s29 offen offset:2048
    buffer_load_dwordx4 v[4:7], v136, s[12:15], s29 offen offset:3072
    s_add_u32 s29, s29, 4096
    buffer_load_dwordx4 v[4:7], v136, s[12:15], s29 offen offset:0
    buffer_load_dwordx4 v[4:7], v136, s[12:15], s29 offen offset:1024
    buffer_load_dwordx4 v[4:7], v136, s[12:15], s29 offen offset:2048
    buffer_load_dwordx4 v[4:7], v136, s[12:15], s29 offen offset:3072
    s_add_u32 s29, s29, 4096
    buffer_load_dwordx4 v[4:7], v136, s[12:15], s29 offen offset:0
    buffer_load_dwordx4 v[4:7], v136, s[12:15], s29 offen offset:1024
    buffer_load_dwordx4 v[4:7], v136, s[12:15], s29 offen offset:2048
    buffer_load_dwordx4 v[4:7], v136, s[12:15], s29 offen offset:3072
    s_add_u32 s29, s29, 4096
    buffer_load_dwordx4 v[4:7], v136, s[12:15], s29 offen offset:0
    buffer_load_dwordx4 v[4:7], v136, s[12:15], s29 offen offset:1024
    s_getpc_b64 s[28:29]
L_cpf3:
    s_add_u32 s28, s28, k3_kernel-L_cpf3
    s_addc_u32 s29, s29, 0
    global_load_dwordx4 v[4:7], v136, s[28:29] offset:0
    global_load_dwordx4 v[4:7], v136, s[28:29] offset:1024
    global_load_dwordx4 v[4:7], v136, s[28:29] offset:2048
    global_load_dwordx4 v[4:7], v136, s[28:29] offset:3072
    s_add_u32 s28, s28, 4096
    s_addc_u32 s29, s29, 0
    global_load_dwordx4 v[4:7], v136, s[28:29] offset:0
    global_load_dwordx4 v[4:7], v136, s[28:29] offset:1024
    global_load_dwordx4 v[4:7], v136, s[28:29] offset:2048
    global_load_dwordx4 v[4:7], v136, s[28:29] offset:3072
    s_add_u32 s28, s28, 4096
    s_addc_u32 s29, s29, 0
    global_load_dwordx4 v[4:7], v136, s[28:29] offset:0
    global_load_dwordx4 v[4:7], v136, s[28:29] offset:1024
    global_load_dwordx4 v[4:7], v136, s[28:29] offset:2048
    global_load_dwordx4 v[4:7], v136, s[28:29] offset:3072
    s_add_u32 s28, s28, 4096
    s_addc_u32 s29, s29, 0
    global_load_dwordx4 v[4:7], v136, s[28:29] offset:0
    s_cmp_lg_u32 s2, 0
    s_cbranch_scc1 L_k2_end
    v_mov_b32 v8, 0
    v_mov_b32 v9, 0
    v_mov_b32 v10, 0
    v_mov_b32 v11, 0
    s_lshl_b32 s28, s24, 12
    s_add_u32 s28, s28, 30777344
    buffer_store_dwordx4 v[8:11], v136, s[12:15], s28 offen
    buffer_store_dwordx4 v[8:11], v136, s[12:15], s28 offen offset:1024
    buffer_store_dwordx4 v[8:11], v136, s[12:15], s28 offen offset:2048
    buffer_store_dwordx4 v[8:11], v136, s[12:15], s28 offen offset:3072
    s_endpgm
L_k2_compute:
    v_and_b32 v137, 31, v1
    v_lshrrev_b32 v138, 5, v1
    v_lshlrev_b32 v2, 3, v137
    v_lshl_add_u32 v2, v138, 11, v2
    s_lshr_b32 s28, s24, 2
    s_bfe_u32 s31, s24, 0x10001
    s_lshl_b32 s30, s26, 1
    s_add_u32 s30, s30, s31
    s_mul_i32 s30, s30, 10240
    s_and_b32 s31, s24, 1
    s_lshl_b32 s31, s31, 9
    s_add_u32 s30, s30, s31
    s_add_u32 s30, s30, s27
    s_add_u32 s30, s30, 5242880
    s_lshl_b32 s31, s28, 8
    s_xor_b32 s29, s31, 256
    s_add_u32 s29, s29, s30
    s_add_u32 s30, s30, s31
    s_add_u32 s31, s30, 4096
    s_add_u32 s34, s29, 4096
    v_lshlrev_b32 v139, 3, v137
    s_waitcnt lgkmcnt(0)
    s_mov_b32 s12, s8
    s_mov_b32 s13, s9
    buffer_load_dwordx2 v[4:5], v2, s[12:15], s30 offen
    buffer_load_dwordx2 v[6:7], v2, s[12:15], s30 offen offset:1024
    buffer_load_dwordx2 v[8:9], v139, s[12:15], s31 offen
    buffer_load_dwordx2 v[10:11], v2, s[12:15], s29 offen
    buffer_load_dwordx2 v[12:13], v2, s[12:15], s29 offen offset:1024
    buffer_load_dwordx2 v[14:15], v139, s[12:15], s34 offen
    s_lshl_b32 s36, s2, 3
    s_add_u32 s36, s36, s24
    s_mov_b32 s51, 0x20000
    s_mov_b32 s52, s8
    s_mov_b32 s53, s9
    s_mov_b32 s54, 30785536
    s_mov_b32 s55, 0x20000
    s_cmp_ge_u32 s36, 1120
    s_cbranch_scc1 L_rp_do
    s_mul_i32 s37, s36, 2341
    s_lshr_b32 s37, s37, 16
    s_mul_i32 s38, s37, 28
    s_sub_u32 s38, s36, s38
    s_mul_i32 s39, s37, 205
    s_lshr_b32 s39, s39, 11
    s_mul_i32 s48, s39, 10
    s_sub_u32 s37, s37, s48
    s_mul_i32 s60, s39, 1146880
    s_mul_i32 s48, s37, 28672
    s_add_u32 s60, s60, s48
    s_lshl_b32 s48, s38, 10
    s_add_u32 s60, s60, s48
    s_add_u32 s60, s60, 22937600
    s_add_u32 s61, s60, 286720
    s_add_u32 s62, s60, 573440
    s_add_u32 s63, s60, 860160
    s_mul_i32 s37, s37, 221184
    s_mul_i32 s39, s39, 896
    s_add_u32 s56, s37, s39
    s_add_u32 s57, s56, 224
    s_add_u32 s58, s56, 448
    s_add_u32 s39, s39, 672
    s_min_u32 s39, s39, 3232
    s_add_u32 s59, s37, s39
    s_cmp_lt_u32 s38, 14
    s_cselect_b32 s48, s44, s46
    s_cselect_b32 s49, s45, s47
    s_cselect_b32 s37, 0, 14
    s_sub_u32 s38, s38, s37
    s_lshl_b32 s38, s38, 6
    s_mov_b32 s50, 2211840
    v_add_u32 v160, s38, v1
    v_mul_u32_u24 v144, 4682, v160
    v_lshrrev_b32 v144, 16, v144
    v_mul_u32_u24 v145, 224, v144
    v_lshlrev_b32 v160, 4, v160
    v_sub_u32 v160, v160, v145
    v_bfe_u32 v145, v144, 2, 1
    v_bfe_u32 v146, v144, 3, 1
    v_and_b32 v144, 0x33, v144
    v_lshl_or_b32 v144, v145, 3, v144
    v_lshl_or_b32 v144, v146, 2, v144
    v_mul_u32_u24 v144, 3456, v144
    v_add_u32 v160, v160, v144
    s_branch L_rp_issue
L_rp_do:
    s_cmp_lt_u32 s36, 1660
    s_mov_b32 s37, 1660
    s_cmov_b32 s37, 1120
    s_cselect_b32 s48, s42, s40
    s_cselect_b32 s49, s43, s41
    s_mov_b32 s50, 819200
    s_cmov_b32 s50, 2211840
    s_cselect_b32 s39, 27, 10
    s_mov_b32 s60, 29736960
    s_cmov_b32 s60, 27525120
    s_sub_u32 s37, s36, s37
    s_mul_i32 s38, s37, 6554
    s_lshr_b32 s38, s38, 16
    s_mul_i32 s56, s38, 10
    s_sub_u32 s37, s37, s56
    s_cmp_ge_u32 s38, s39
    s_cselect_b32 s56, s39, 0
    s_cselect_b32 s57, 4, 0
    s_sub_u32 s38, s38, s56
    s_mul_i32 s58, s39, 10240
    s_mul_i32 s57, s57, s58
    s_add_u32 s60, s60, s57
    s_mul_i32 s57, s38, 10240
    s_add_u32 s60, s60, s57
    s_lshl_b32 s57, s37, 10
    s_add_u32 s60, s60, s57
    s_add_u32 s61, s60, s58
    s_add_u32 s62, s61, s58
    s_add_u32 s63, s62, s58
    s_cselect_b32 s56, 0, 0
    s_lshl_b32 s37, s37, 6
    v_add_u32 v160, s37, v1
    v_mul_u32_u24 v144, 6554, v160
    v_lshrrev_b32 v144, 16, v144
    v_mul_u32_u24 v145, 10, v144
    v_sub_u32 v160, v160, v145
    v_bfe_u32 v145, v144, 2, 1
    v_bfe_u32 v146, v144, 3, 1
    v_lshrrev_b32 v147, 4, v144
    v_and_b32 v148, 3, v144
    s_cmp_lt_u32 s38, 8
    s_cselect_b32 s56, 20, 80
    s_cselect_b32 s57, 4, 40
    s_cselect_b32 s58, 8, 20
    s_mov_b32 s59, 320
    s_cmov_b32 s59, 80
    s_cselect_b32 s37, 0, 4294964752
    s_cmp_lt_u32 s36, 1660
    s_cselect_b32 s56, 16, s56
    s_cselect_b32 s57, 8, s57
    s_cselect_b32 s58, 4, s58
    s_cselect_b32 s59, 64, s59
    s_cselect_b32 s37, 0, s37
    s_mul_i32 s59, s59, s38
    s_add_u32 s59, s59, s37
    v_mad_u32_u24 v148, v147, s56, v148
    v_mad_u32_u24 v148, v145, s57, v148
    v_mad_u32_u24 v148, v146, s58, v148
    v_mul_u32_u24 v148, 1280, v148
    v_lshl_add_u32 v160, v160, 4, v148
    s_mul_i32 s56, s59, 1280
    s_cmp_lt_u32 s36, 1660
    s_mov_b32 s37, 1760
    s_cmov_b32 s37, 1390
    s_cmp_ge_u32 s36, s37
    s_cselect_b32 s37, 640, 0
    s_add_u32 s56, s56, s37
    s_add_u32 s57, s56, 160
    s_add_u32 s58, s56, 320
    s_add_u32 s59, s56, 480
    s_cmp_lt_u32 s36, 1860
    s_cselect_b32 s50, s50, 0
    s_cselect_b32 s54, s54, 0
L_rp_issue:
    s_mul_i32 s29, s28, 81920
    v_add_u32 v2, s29, v2
    v_mul_u32_u24 v3, 320, v138
    v_lshl_add_u32 v3, v137, 4, v3
    s_add_u32 s29, s29, 5120
    v_add_u32 v3, s29, v3
    s_mov_b32 s32, 0x000fffff
    s_mov_b32 s33, 0x000fffff
    s_mov_b32 s38, -1
    s_mov_b32 s39, 0
    s_mov_b32 s34, 0
    v_cmp_eq_u32 vcc, 20, v137
    v_mov_b32 v140, 0x3f803f80
    s_nop 0
    v_cndmask_b32 v24, 0, v140, vcc
    v_cndmask_b32 v25, 0, v140, vcc
    v_cndmask_b32 v26, 0, v140, vcc
    v_cndmask_b32 v27, 0, v140, vcc
    v_cndmask_b32 v28, 0, v140, vcc
    v_cndmask_b32 v29, 0, v140, vcc
    v_cndmask_b32 v30, 0, v140, vcc
    v_cndmask_b32 v31, 0, v140, vcc
    v_mov_b32 v104, 0
    v_mov_b32 v105, 0
    v_mov_b32 v106, 0
    v_mov_b32 v107, 0
    v_mov_b32 v108, 0
    v_mov_b32 v109, 0
    v_mov_b32 v110, 0
    v_mov_b32 v111, 0
    v_mov_b32 v112, 0
    v_mov_b32 v113, 0
    v_mov_b32 v114, 0
    v_mov_b32 v115, 0
    v_mov_b32 v116, 0
    v_mov_b32 v117, 0
    v_mov_b32 v118, 0
    v_mov_b32 v119, 0
    v_mov_b32 v120, 0
    v_mov_b32 v121, 0
    v_mov_b32 v122, 0
    v_mov_b32 v123, 0
    v_mov_b32 v124, 0
    v_mov_b32 v125, 0
    v_mov_b32 v126, 0
    v_mov_b32 v127, 0
    v_mov_b32 v128, 0
    v_mov_b32 v129, 0
    v_mov_b32 v130, 0
    v_mov_b32 v131, 0
    v_mov_b32 v132, 0
    v_mov_b32 v133, 0
    v_mov_b32 v134, 0
    v_mov_b32 v135, 0
    v_mov_b32 v36, 0
    v_mov_b32 v37, 0
    v_mov_b32 v38, 0
    v_mov_b32 v39, 0
    v_mov_b32 v20, 0
    v_mov_b32 v21, 0
    v_mov_b32 v22, 0
    v_mov_b32 v23, 0
    s_lshl_b32 s30, s26, 3
    s_and_b32 s31, s24, 3
    s_lshl_b32 s31, s31, 1
    s_add_u32 s30, s30, s31
    s_add_u32 s30, s30, s28
    s_mul_i32 s30, s30, 40960
    s_add_u32 s30, s30, 10485760
    s_lshl_b32 s10, s25, 10
    s_add_u32 s10, s10, s30
    s_lshr_b32 s11, s25, 1
    s_lshl_b32 s11, s11, 9
    s_and_b32 s31, s25, 1
    s_lshl_b32 s31, s31, 3
    s_add_u32 s11, s11, s31
    s_add_u32 s11, s11, s30
    s_add_u32 s11, s11, 32768
    s_waitcnt vmcnt(0)
    s_mov_b32 exec_lo, 0
    v_mov_b32 v8, 0
    v_mov_b32 v9, 0
    v_mov_b32 v14, 0
    v_mov_b32 v15, 0
    s_mov_b64 exec, -1
    s_barrier
    ds_read2_b64 v[16:19], v2 offset0:0 offset1:128
    ds_read_b64 v[20:21], v2 offset:4096
    s_waitcnt lgkmcnt(0)
    v_mfma_f32_32x32x16_bf16 v[72:87], v[16:19], v[4:7], 0
    v_mfma_f32_32x32x8_bf16 v[72:87], v[20:21], v[8:9], v[72:87]
    v_mfma_f32_32x32x16_bf16 v[88:103], v[16:19], v[10:13], 0
    v_mfma_f32_32x32x8_bf16 v[88:103], v[20:21], v[14:15], v[88:103]
    s_nop 9
    v_max3_f32 v140, v72, v73, v74
    v_max3_f32 v140, v140, v75, v76
    v_max3_f32 v140, v140, v77, v78
    v_max3_f32 v140, v140, v79, v80
    v_max3_f32 v140, v140, v81, v82
    v_max3_f32 v140, v140, v83, v84
    v_max3_f32 v140, v140, v85, v86
    v_max_f32 v140, v140, v87
    v_mov_b32 v142, v140
    s_nop 1
    v_permlane32_swap_b32 v142, v140
    v_max_f32 v140, v140, v142
    v_sub_f32 v40, 0, v140
    v_sub_f32 v41, 0, v140
    v_mov_b64 v[42:43], v[40:41]
    v_mov_b64 v[44:45], v[40:41]
    v_mov_b64 v[46:47], v[40:41]
    v_mov_b64 v[48:49], v[40:41]
    v_mov_b64 v[50:51], v[40:41]
    v_mov_b64 v[52:53], v[40:41]
    v_mov_b64 v[54:55], v[40:41]
    s_nop 1
    v_mfma_f32_32x32x16_bf16 v[72:87], v[16:19], v[4:7], v[40:55]
    v_mfma_f32_32x32x8_bf16 v[72:87], v[20:21], v[8:9], v[72:87]
    v_max3_f32 v141, v88, v89, v90
    v_max3_f32 v141, v141, v91, v92
    v_max3_f32 v141, v141, v93, v94
    v_max3_f32 v141, v141, v95, v96
    v_max3_f32 v141, v141, v97, v98
    v_max3_f32 v141, v141, v99, v100
    v_max3_f32 v141, v141, v101, v102
    v_max_f32 v141, v141, v103
    v_mov_b32 v143, v141
    s_nop 1
    v_permlane32_swap_b32 v143, v141
    v_max_f32 v141, v141, v143
    v_sub_f32 v56, 0, v141
    v_sub_f32 v57, 0, v141
    v_mov_b64 v[58:59], v[56:57]
    v_mov_b64 v[60:61], v[56:57]
    v_mov_b64 v[62:63], v[56:57]
    v_mov_b64 v[64:65], v[56:57]
    v_mov_b64 v[66:67], v[56:57]
    v_mov_b64 v[68:69], v[56:57]
    v_mov_b64 v[70:71], v[56:57]
    s_mov_b32 s35, 0
    s_branch L_k2_loop
L_k2_restart2:
    v_mfma_f32_32x32x16_bf16 v[72:87], v[16:19], v[4:7], v[40:55]
    v_mfma_f32_32x32x8_bf16 v[72:87], v[20:21], v[8:9], v[72:87]
    s_nop 10
.p2align 6
L_k2_loop:
    s_setprio 0
    v_mfma_f32_32x32x16_bf16 v[88:103], v[16:19], v[10:13], v[56:71]
    v_exp_f32 v72, v72
    v_exp_f32 v73, v73
    v_exp_f32 v74, v74
    v_exp_f32 v75, v75
    v_exp_f32 v76, v76
    v_mfma_f32_32x32x16_bf16 v[120:135], v[28:31], v[36:39], v[120:135]
    s_mov_b64 exec, s[32:33]
    ds_read_b128 v[24:27], v3 offset:0
    ds_read_b128 v[28:31], v3 offset:640
    s_mov_b64 exec, -1
    v_exp_f32 v77, v77
    v_exp_f32 v78, v78
    v_exp_f32 v79, v79
    v_cvt_pk_bf16_f32 v32, v72, v73
    v_cvt_pk_bf16_f32 v33, v74, v75
    v_exp_f32 v80, v80
    v_mfma_f32_32x32x8_bf16 v[88:103], v[20:21], v[14:15], v[88:103]
    ds_read2_b64 v[16:19], v2 offset0:32 offset1:160
    ds_read_b64 v[20:21], v2 offset:4352
    v_cvt_pk_bf16_f32 v34, v76, v77
    v_cvt_pk_bf16_f32 v35, v78, v79
    v_exp_f32 v81, v81
    v_exp_f32 v82, v82
    v_exp_f32 v83, v83
    v_exp_f32 v84, v84
    s_waitcnt lgkmcnt(3)
    v_mfma_f32_32x32x16_bf16 v[104:119], v[24:27], v[32:35], v[104:119]
    v_cvt_pk_bf16_f32 v36, v80, v81
    v_cvt_pk_bf16_f32 v37, v82, v83
    v_exp_f32 v85, v85
    v_exp_f32 v86, v86
    v_exp_f32 v87, v87
    v_cvt_pk_bf16_f32 v38, v84, v85
    v_cvt_pk_bf16_f32 v39, v86, v87
    s_setprio 2
    s_waitcnt lgkmcnt(0)
    v_mfma_f32_32x32x16_bf16 v[72:87], v[16:19], v[4:7], v[40:55]
    v_exp_f32 v88, v88
    v_exp_f32 v89, v89
    v_exp_f32 v90, v90
    v_exp_f32 v91, v91
    v_exp_f32 v92, v92
    v_mfma_f32_32x32x16_bf16 v[104:119], v[28:31], v[36:39], v[104:119]
    v_exp_f32 v93, v93
    v_exp_f32 v94, v94
    v_exp_f32 v95, v95
    v_cvt_pk_bf16_f32 v32, v88, v89
    v_cvt_pk_bf16_f32 v33, v90, v91
    v_exp_f32 v96, v96
    v_mfma_f32_32x32x8_bf16 v[72:87], v[20:21], v[8:9], v[72:87]
    v_cvt_pk_bf16_f32 v34, v92, v93
    v_cvt_pk_bf16_f32 v35, v94, v95
    v_exp_f32 v97, v97
    v_exp_f32 v98, v98
    v_exp_f32 v99, v99
    v_exp_f32 v100, v100
    v_mfma_f32_32x32x16_bf16 v[120:135], v[24:27], v[32:35], v[120:135]
    v_cvt_pk_bf16_f32 v36, v96, v97
    v_cvt_pk_bf16_f32 v37, v98, v99
    v_exp_f32 v101, v101
    v_exp_f32 v102, v102
    v_exp_f32 v103, v103
    v_cvt_pk_bf16_f32 v38, v100, v101
    v_cvt_pk_bf16_f32 v39, v102, v103
    v_mfma_f32_32x32x16_bf16 v[88:103], v[16:19], v[10:13], v[56:71]
    v_exp_f32 v72, v72
    v_exp_f32 v73, v73
    v_exp_f32 v74, v74
    v_exp_f32 v75, v75
    v_exp_f32 v76, v76
    v_mfma_f32_32x32x16_bf16 v[120:135], v[28:31], v[36:39], v[120:135]
    s_mov_b64 exec, s[32:33]
    ds_read_b128 v[24:27], v3 offset:1280
    ds_read_b128 v[28:31], v3 offset:1920
    s_mov_b64 exec, -1
    v_exp_f32 v77, v77
    v_exp_f32 v78, v78
    v_exp_f32 v79, v79
    v_cvt_pk_bf16_f32 v32, v72, v73
    v_cvt_pk_bf16_f32 v33, v74, v75
    v_exp_f32 v80, v80
    v_mfma_f32_32x32x8_bf16 v[88:103], v[20:21], v[14:15], v[88:103]
    ds_read2_b64 v[16:19], v2 offset0:64 offset1:192
    ds_read_b64 v[20:21], v2 offset:4608
    v_cvt_pk_bf16_f32 v34, v76, v77
    v_cvt_pk_bf16_f32 v35, v78, v79
    v_exp_f32 v81, v81
    v_exp_f32 v82, v82
    v_exp_f32 v83, v83
    v_exp_f32 v84, v84
    s_waitcnt lgkmcnt(3)
    v_mfma_f32_32x32x16_bf16 v[104:119], v[24:27], v[32:35], v[104:119]
    v_cvt_pk_bf16_f32 v36, v80, v81
    v_cvt_pk_bf16_f32 v37, v82, v83
    v_exp_f32 v85, v85
    v_exp_f32 v86, v86
    v_exp_f32 v87, v87
    v_cvt_pk_bf16_f32 v38, v84, v85
    v_cvt_pk_bf16_f32 v39, v86, v87
    s_waitcnt lgkmcnt(0)
    v_mfma_f32_32x32x16_bf16 v[72:87], v[16:19], v[4:7], v[40:55]
    v_exp_f32 v88, v88
    v_exp_f32 v89, v89
    v_exp_f32 v90, v90
    v_exp_f32 v91, v91
    v_exp_f32 v92, v92
    v_mfma_f32_32x32x16_bf16 v[104:119], v[28:31], v[36:39], v[104:119]
    v_exp_f32 v93, v93
    v_exp_f32 v94, v94
    v_exp_f32 v95, v95
    v_cvt_pk_bf16_f32 v32, v88, v89
    v_cvt_pk_bf16_f32 v33, v90, v91
    v_exp_f32 v96, v96
    v_mfma_f32_32x32x8_bf16 v[72:87], v[20:21], v[8:9], v[72:87]
    v_cvt_pk_bf16_f32 v34, v92, v93
    v_cvt_pk_bf16_f32 v35, v94, v95
    v_exp_f32 v97, v97
    v_exp_f32 v98, v98
    v_exp_f32 v99, v99
    v_exp_f32 v100, v100
    v_mfma_f32_32x32x16_bf16 v[120:135], v[24:27], v[32:35], v[120:135]
    v_cvt_pk_bf16_f32 v36, v96, v97
    v_cvt_pk_bf16_f32 v37, v98, v99
    v_exp_f32 v101, v101
    v_exp_f32 v102, v102
    v_exp_f32 v103, v103
    v_cvt_pk_bf16_f32 v38, v100, v101
    v_cvt_pk_bf16_f32 v39, v102, v103
    v_mfma_f32_32x32x16_bf16 v[88:103], v[16:19], v[10:13], v[56:71]
    v_exp_f32 v72, v72
    v_exp_f32 v73, v73
    v_exp_f32 v74, v74
    v_exp_f32 v75, v75
    v_exp_f32 v76, v76
    v_mfma_f32_32x32x16_bf16 v[120:135], v[28:31], v[36:39], v[120:135]
    s_mov_b64 exec, s[32:33]
    ds_read_b128 v[24:27], v3 offset:2560
    ds_read_b128 v[28:31], v3 offset:3200
    s_mov_b64 exec, -1
    v_exp_f32 v77, v77
    v_exp_f32 v78, v78
    v_exp_f32 v79, v79
    v_cvt_pk_bf16_f32 v32, v72, v73
    v_cvt_pk_bf16_f32 v33, v74, v75
    v_exp_f32 v80, v80
    v_mfma_f32_32x32x8_bf16 v[88:103], v[20:21], v[14:15], v[88:103]
    ds_read2_b64 v[16:19], v2 offset0:96 offset1:224
    ds_read_b64 v[20:21], v2 offset:4864
    v_cvt_pk_bf16_f32 v34, v76, v77
    v_cvt_pk_bf16_f32 v35, v78, v79
    v_exp_f32 v81, v81
    v_exp_f32 v82, v82
    v_exp_f32 v83, v83
    v_exp_f32 v84, v84
    s_waitcnt lgkmcnt(3)
    v_mfma_f32_32x32x16_bf16 v[104:119], v[24:27], v[32:35], v[104:119]
    v_cvt_pk_bf16_f32 v36, v80, v81
    v_cvt_pk_bf16_f32 v37, v82, v83
    v_exp_f32 v85, v85
    v_exp_f32 v86, v86
    v_exp_f32 v87, v87
    v_cvt_pk_bf16_f32 v38, v84, v85
    v_cvt_pk_bf16_f32 v39, v86, v87
    s_waitcnt lgkmcnt(0)
    v_mfma_f32_32x32x16_bf16 v[72:87], v[16:19], v[4:7], v[40:55]
    v_exp_f32 v88, v88
    v_exp_f32 v89, v89
    v_exp_f32 v90, v90
    v_exp_f32 v91, v91
    v_exp_f32 v92, v92
    v_mfma_f32_32x32x16_bf16 v[104:119], v[28:31], v[36:39], v[104:119]
    v_exp_f32 v93, v93
    v_exp_f32 v94, v94
    v_exp_f32 v95, v95
    v_cvt_pk_bf16_f32 v32, v88, v89
    v_cvt_pk_bf16_f32 v33, v90, v91
    v_exp_f32 v96, v96
    v_mfma_f32_32x32x8_bf16 v[72:87], v[20:21], v[8:9], v[72:87]
    v_cvt_pk_bf16_f32 v34, v92, v93
    v_cvt_pk_bf16_f32 v35, v94, v95
    v_exp_f32 v97, v97
    v_exp_f32 v98, v98
    v_exp_f32 v99, v99
    v_exp_f32 v100, v100
    v_mfma_f32_32x32x16_bf16 v[120:135], v[24:27], v[32:35], v[120:135]
    v_cvt_pk_bf16_f32 v36, v96, v97
    v_cvt_pk_bf16_f32 v37, v98, v99
    v_exp_f32 v101, v101
    v_exp_f32 v102, v102
    v_exp_f32 v103, v103
    v_cvt_pk_bf16_f32 v38, v100, v101
    v_cvt_pk_bf16_f32 v39, v102, v103
    s_cmp_lt_u32 s35, 6
    s_cbranch_scc1 L_k2_side
L_k2_nosync:
    v_mfma_f32_32x32x16_bf16 v[88:103], v[16:19], v[10:13], v[56:71]
    v_exp_f32 v72, v72
    v_exp_f32 v73, v73
    v_exp_f32 v74, v74
    v_exp_f32 v75, v75
    v_exp_f32 v76, v76
    v_mfma_f32_32x32x16_bf16 v[120:135], v[28:31], v[36:39], v[120:135]
    s_mov_b64 exec, s[32:33]
    ds_read_b128 v[24:27], v3 offset:3840
    ds_read_b128 v[28:31], v3 offset:4480
    s_mov_b64 exec, -1
    v_exp_f32 v77, v77
    v_exp_f32 v78, v78
    v_exp_f32 v79, v79
    v_cvt_pk_bf16_f32 v32, v72, v73
    v_cvt_pk_bf16_f32 v33, v74, v75
    v_exp_f32 v80, v80
    v_mfma_f32_32x32x8_bf16 v[88:103], v[20:21], v[14:15], v[88:103]
    v_add_u32 v2, 10240, v2
    ds_read2_b64 v[16:19], v2 offset0:0 offset1:128
    ds_read_b64 v[20:21], v2 offset:4096
    v_cvt_pk_bf16_f32 v34, v76, v77
    v_cvt_pk_bf16_f32 v35, v78, v79
    v_exp_f32 v81, v81
    v_exp_f32 v82, v82
    v_exp_f32 v83, v83
    v_exp_f32 v84, v84
    s_waitcnt lgkmcnt(3)
    v_mfma_f32_32x32x16_bf16 v[104:119], v[24:27], v[32:35], v[104:119]
    v_cvt_pk_bf16_f32 v36, v80, v81
    v_cvt_pk_bf16_f32 v37, v82, v83
    v_exp_f32 v85, v85
    v_exp_f32 v86, v86
    v_exp_f32 v87, v87
    v_cvt_pk_bf16_f32 v38, v84, v85
    v_cvt_pk_bf16_f32 v39, v86, v87
    s_waitcnt lgkmcnt(0)
    v_mfma_f32_32x32x16_bf16 v[72:87], v[16:19], v[4:7], v[40:55]
    v_exp_f32 v88, v88
    v_exp_f32 v89, v89
    v_exp_f32 v90, v90
    v_exp_f32 v91, v91
    v_exp_f32 v92, v92
    v_mfma_f32_32x32x16_bf16 v[104:119], v[28:31], v[36:39], v[104:119]
    v_exp_f32 v93, v93
    v_exp_f32 v94, v94
    v_exp_f32 v95, v95
    v_cvt_pk_bf16_f32 v32, v88, v89
    v_cvt_pk_bf16_f32 v33, v90, v91
    v_exp_f32 v96, v96
    v_mfma_f32_32x32x8_bf16 v[72:87], v[20:21], v[8:9], v[72:87]
    v_cvt_pk_bf16_f32 v34, v92, v93
    v_cvt_pk_bf16_f32 v35, v94, v95
    v_exp_f32 v97, v97
    v_exp_f32 v98, v98
    v_exp_f32 v99, v99
    v_exp_f32 v100, v100
    v_mfma_f32_32x32x16_bf16 v[120:135], v[24:27], v[32:35], v[120:135]
    v_cvt_pk_bf16_f32 v36, v96, v97
    v_cvt_pk_bf16_f32 v37, v98, v99
    v_exp_f32 v101, v101
    v_exp_f32 v102, v102
    v_exp_f32 v103, v103
    v_cvt_pk_bf16_f32 v38, v100, v101
    v_add_u32 v3, 10240, v3
    s_add_u32 s35, s35, 1
    s_bitcmp0_b32 s35, 3
    v_cvt_pk_bf16_f32 v39, v102, v103
    s_cbranch_scc1 L_k2_loop
    s_nop 0
    v_mfma_f32_32x32x16_bf16 v[120:135], v[28:31], v[36:39], v[120:135]
    s_nop 11
    s_cmp_lg_u32 s34, 0
    s_cbranch_scc1 L_k2_fin
    s_mov_b32 exec_lo, 0
    v_max_f32 v140, v112, v128
    v_cmp_u_f32 s[36:37], v112, v128
    v_cmp_nge_f32 vcc, 0x5f800000, v140
    s_mov_b64 exec, -1
    s_or_b64 vcc, vcc, s[36:37]
    s_cbranch_vccz L_k2_fin
    s_mov_b32 s34, 1
    v_subrev_u32 v2, 81920, v2
    v_subrev_u32 v3, 81920, v3
    v_mov_b32 v140, 0xff800000
    v_mov_b32 v141, 0xff800000
    s_mov_b32 s35, 0
L_k2_maxloop:
    ds_read2_b64 v[16:19], v2 offset0:0 offset1:128
    ds_read_b64 v[20:21], v2 offset:4096
    s_waitcnt lgkmcnt(0)
    v_mfma_f32_32x32x16_bf16 v[72:87], v[16:19], v[4:7], 0
    v_mfma_f32_32x32x8_bf16 v[72:87], v[20:21], v[8:9], v[72:87]
    v_mfma_f32_32x32x16_bf16 v[88:103], v[16:19], v[10:13], 0
    v_mfma_f32_32x32x8_bf16 v[88:103], v[20:21], v[14:15], v[88:103]
    s_nop 9
    v_max3_f32 v140, v140, v72, v73
    v_max3_f32 v140, v140, v74, v75
    v_max3_f32 v140, v140, v76, v77
    v_max3_f32 v140, v140, v78, v79
    v_max3_f32 v140, v140, v80, v81
    v_max3_f32 v140, v140, v82, v83
    v_max3_f32 v140, v140, v84, v85
    v_max3_f32 v140, v140, v86, v87
    v_max3_f32 v141, v141, v88, v89
    v_max3_f32 v141, v141, v90, v91
    v_max3_f32 v141, v141, v92, v93
    v_max3_f32 v141, v141, v94, v95
    v_max3_f32 v141, v141, v96, v97
    v_max3_f32 v141, v141, v98, v99
    v_max3_f32 v141, v141, v100, v101
    v_max3_f32 v141, v141, v102, v103
    ds_read2_b64 v[16:19], v2 offset0:32 offset1:160
    ds_read_b64 v[20:21], v2 offset:4352
    s_waitcnt lgkmcnt(0)
    v_mfma_f32_32x32x16_bf16 v[72:87], v[16:19], v[4:7], 0
    v_mfma_f32_32x32x8_bf16 v[72:87], v[20:21], v[8:9], v[72:87]
    v_mfma_f32_32x32x16_bf16 v[88:103], v[16:19], v[10:13], 0
    v_mfma_f32_32x32x8_bf16 v[88:103], v[20:21], v[14:15], v[88:103]
    s_nop 9
    v_max3_f32 v140, v140, v72, v73
    v_max3_f32 v140, v140, v74, v75
    v_max3_f32 v140, v140, v76, v77
    v_max3_f32 v140, v140, v78, v79
    v_max3_f32 v140, v140, v80, v81
    v_max3_f32 v140, v140, v82, v83
    v_max3_f32 v140, v140, v84, v85
    v_max3_f32 v140, v140, v86, v87
    v_max3_f32 v141, v141, v88, v89
    v_max3_f32 v141, v141, v90, v91
    v_max3_f32 v141, v141, v92, v93
    v_max3_f32 v141, v141, v94, v95
    v_max3_f32 v141, v141, v96, v97
    v_max3_f32 v141, v141, v98, v99
    v_max3_f32 v141, v141, v100, v101
    v_max3_f32 v141, v141, v102, v103
    ds_read2_b64 v[16:19], v2 offset0:64 offset1:192
    ds_read_b64 v[20:21], v2 offset:4608
    s_waitcnt lgkmcnt(0)
    v_mfma_f32_32x32x16_bf16 v[72:87], v[16:19], v[4:7], 0
    v_mfma_f32_32x32x8_bf16 v[72:87], v[20:21], v[8:9], v[72:87]
    v_mfma_f32_32x32x16_bf16 v[88:103], v[16:19], v[10:13], 0
    v_mfma_f32_32x32x8_bf16 v[88:103], v[20:21], v[14:15], v[88:103]
    s_nop 9
    v_max3_f32 v140, v140, v72, v73
    v_max3_f32 v140, v140, v74, v75
    v_max3_f32 v140, v140, v76, v77
    v_max3_f32 v140, v140, v78, v79
    v_max3_f32 v140, v140, v80, v81
    v_max3_f32 v140, v140, v82, v83
    v_max3_f32 v140, v140, v84, v85
    v_max3_f32 v140, v140, v86, v87
    v_max3_f32 v141, v141, v88, v89
    v_max3_f32 v141, v141, v90, v91
    v_max3_f32 v141, v141, v92, v93
    v_max3_f32 v141, v141, v94, v95
    v_max3_f32 v141, v141, v96, v97
    v_max3_f32 v141, v141, v98, v99
    v_max3_f32 v141, v141, v100, v101
    v_max3_f32 v141, v141, v102, v103
    ds_read2_b64 v[16:19], v2 offset0:96 offset1:224
    ds_read_b64 v[20:21], v2 offset:4864
    s_waitcnt lgkmcnt(0)
    v_mfma_f32_32x32x16_bf16 v[72:87], v[16:19], v[4:7], 0
    v_mfma_f32_32x32x8_bf16 v[72:87], v[20:21], v[8:9], v[72:87]
    v_mfma_f32_32x32x16_bf16 v[88:103], v[16:19], v[10:13], 0
    v_mfma_f32_32x32x8_bf16 v[88:103], v[20:21], v[14:15], v[88:103]
    s_nop 9
    v_max3_f32 v140, v140, v72, v73
    v_max3_f32 v140, v140, v74, v75
    v_max3_f32 v140, v140, v76, v77
    v_max3_f32 v140, v140, v78, v79
    v_max3_f32 v140, v140, v80, v81
    v_max3_f32 v140, v140, v82, v83
    v_max3_f32 v140, v140, v84, v85
    v_max3_f32 v140, v140, v86, v87
    v_max3_f32 v141, v141, v88, v89
    v_max3_f32 v141, v141, v90, v91
    v_max3_f32 v141, v141, v92, v93
    v_max3_f32 v141, v141, v94, v95
    v_max3_f32 v141, v141, v96, v97
    v_max3_f32 v141, v141, v98, v99
    v_max3_f32 v141, v141, v100, v101
    v_max3_f32 v141, v141, v102, v103
    v_add_u32 v2, 10240, v2
    s_add_u32 s35, s35, 1
    s_cmp_lt_u32 s35, 8
    s_cbranch_scc1 L_k2_maxloop
    v_subrev_u32 v2, 81920, v2
    v_mov_b32 v142, v140
    v_mov_b32 v143, v141
    s_nop 0
    v_permlane32_swap_b32 v142, v140
    v_permlane32_swap_b32 v143, v141
    v_max_f32 v140, v140, v142
    v_max_f32 v141, v141, v143
    v_sub_f32 v40, 0, v140
    v_sub_f32 v41, 0, v140
    v_mov_b64 v[42:43], v[40:41]
    v_mov_b64 v[44:45], v[40:41]
    v_mov_b64 v[46:47], v[40:41]
    v_mov_b64 v[48:49], v[40:41]
    v_mov_b64 v[50:51], v[40:41]
    v_mov_b64 v[52:53], v[40:41]
    v_mov_b64 v[54:55], v[40:41]
    v_sub_f32 v56, 0, v141
    v_sub_f32 v57, 0, v141
    v_mov_b64 v[58:59], v[56:57]
    v_mov_b64 v[60:61], v[56:57]
    v_mov_b64 v[62:63], v[56:57]
    v_mov_b64 v[64:65], v[56:57]
    v_mov_b64 v[66:67], v[56:57]
    v_mov_b64 v[68:69], v[56:57]
    v_mov_b64 v[70:71], v[56:57]
    v_mov_b32 v104, 0
    v_mov_b32 v105, 0
    v_mov_b32 v106, 0
    v_mov_b32 v107, 0
    v_mov_b32 v108, 0
    v_mov_b32 v109, 0
    v_mov_b32 v110, 0
    v_mov_b32 v111, 0
    v_mov_b32 v112, 0
    v_mov_b32 v113, 0
    v_mov_b32 v114, 0
    v_mov_b32 v115, 0
    v_mov_b32 v116, 0
    v_mov_b32 v117, 0
    v_mov_b32 v118, 0
    v_mov_b32 v119, 0
    v_mov_b32 v120, 0
    v_mov_b32 v121, 0
    v_mov_b32 v122, 0
    v_mov_b32 v123, 0
    v_mov_b32 v124, 0
    v_mov_b32 v125, 0
    v_mov_b32 v126, 0
    v_mov_b32 v127, 0
    v_mov_b32 v128, 0
    v_mov_b32 v129, 0
    v_mov_b32 v130, 0
    v_mov_b32 v131, 0
    v_mov_b32 v132, 0
    v_mov_b32 v133, 0
    v_mov_b32 v134, 0
    v_mov_b32 v135, 0
    v_mov_b32 v36, 0
    v_mov_b32 v37, 0
    v_mov_b32 v38, 0
    v_mov_b32 v39, 0
    ds_read2_b64 v[16:19], v2 offset0:0 offset1:128
    ds_read_b64 v[20:21], v2 offset:4096
    s_waitcnt lgkmcnt(0)
    s_mov_b32 s35, 16
    s_branch L_k2_restart2
L_k2_fin:
    s_lshl_b32 s30, s24, 12
    v_add_u32 v140, s30, v136
    v_xor_b32 v141, 0x4000, v140
    v_mov_b32 v132, v56
    s_waitcnt lgkmcnt(0)
    s_barrier
    ds_write_b128 v140, v[120:123] offset:0
    ds_write_b128 v140, v[124:127] offset:1024
    ds_write_b128 v140, v[128:131] offset:2048
    ds_write_b128 v140, v[132:135] offset:3072
    s_waitcnt lgkmcnt(0)
    s_barrier
    ds_read_b128 v[120:123], v141 offset:0
    ds_read_b128 v[124:127], v141 offset:1024
    ds_read_b128 v[128:131], v141 offset:2048
    ds_read_b128 v[132:135], v141 offset:3072
    s_waitcnt lgkmcnt(0)
    v_min_f32 v140, v40, v132
    v_sub_f32 v141, v140, v40
    v_sub_f32 v142, v140, v132
    v_exp_f32 v141, v141
    v_exp_f32 v142, v142
    v_mul_f32 v140, v112, v141
    v_fmac_f32 v140, v128, v142
    v_mov_b32 v143, v140
    s_nop 1
    v_permlane32_swap_b32 v143, v140
    v_rcp_f32 v140, v140
    s_nop 0
    v_mul_f32 v141, v141, v140
    v_mul_f32 v142, v142, v140
    v_mul_f32 v104, v104, v141
    v_mul_f32 v105, v105, v141
    v_mul_f32 v106, v106, v141
    v_mul_f32 v107, v107, v141
    v_mul_f32 v108, v108, v141
    v_mul_f32 v109, v109, v141
    v_mul_f32 v110, v110, v141
    v_mul_f32 v111, v111, v141
    v_mul_f32 v112, v112, v141
    v_mul_f32 v113, v113, v141
    v_mul_f32 v114, v114, v141
    v_mul_f32 v115, v115, v141
    v_fmac_f32 v104, v120, v142
    v_fmac_f32 v105, v121, v142
    v_fmac_f32 v106, v122, v142
    v_fmac_f32 v107, v123, v142
    v_fmac_f32 v108, v124, v142
    v_fmac_f32 v109, v125, v142
    v_fmac_f32 v110, v126, v142
    v_fmac_f32 v111, v127, v142
    v_fmac_f32 v112, v128, v142
    v_fmac_f32 v113, v129, v142
    v_fmac_f32 v114, v130, v142
    v_fmac_f32 v115, v131, v142
    v_cvt_pk_bf16_f32 v32, v104, v105
    v_cvt_pk_bf16_f32 v33, v106, v107
    v_cvt_pk_bf16_f32 v34, v108, v109
    v_cvt_pk_bf16_f32 v35, v110, v111
    v_cvt_pk_bf16_f32 v36, v112, v113
    v_cvt_pk_bf16_f32 v37, v114, v115
    buffer_store_dwordx4 v[32:35], v136, s[12:15], s10 offen
    s_mov_b32 exec_hi, 0
    buffer_store_dwordx2 v[36:37], v136, s[12:15], s11 offen
L_k2_end:
    s_endpgm
L_k2_side:
    s_cmp_eq_u32 s35, 4
    s_cbranch_scc1 L_k2_side4
    s_cmp_eq_u32 s35, 3
    s_cbranch_scc1 L_k2_side3
    s_cmp_eq_u32 s35, 2
    s_cbranch_scc1 L_k2_side2
    s_barrier
    s_branch L_k2_nosync
L_k2_side3:
    s_branch L_k2_nosync
L_k2_side2:
    buffer_load_dwordx4 v[144:147], v160, s[48:51], s56 offen
    buffer_load_dwordx4 v[148:151], v160, s[48:51], s57 offen
    buffer_load_dwordx4 v[152:155], v160, s[48:51], s58 offen
    buffer_load_dwordx4 v[156:159], v160, s[48:51], s59 offen
    s_branch L_k2_nosync
L_k2_side4:
    s_waitcnt vmcnt(0)
    buffer_store_dwordx4 v[144:147], v136, s[52:55], s60 offen sc1
    buffer_store_dwordx4 v[148:151], v136, s[52:55], s61 offen sc1
    buffer_store_dwordx4 v[152:155], v136, s[52:55], s62 offen sc1
    buffer_store_dwordx4 v[156:159], v136, s[52:55], s63 offen sc1
    s_branch L_k2_nosync
k2_kernel_codeend:
.p2align 8
.globl k3_kernel
.type k3_kernel,@function
k3_kernel:
    s_load_dwordx2 s[8:9], s[0:1], 72
    s_load_dwordx2 s[4:5], s[0:1], 0
    s_load_dwordx2 s[6:7], s[0:1], 56
    s_cmp_ge_u32 s2, 256
    s_cbranch_scc1 L_kf_end
    v_lshrrev_b32 v2, 6, v0
    v_and_b32 v1, 63, v0
    s_mov_b32 s14, 30785536
    v_readfirstlane_b32 s24, v2
    s_mov_b32 s15, 0x20000
    s_and_b32 s10, s2, 7
    s_lshl_b32 s10, s10, 2
    s_bfe_u32 s11, s2, 0x20003
    s_add_u32 s25, s10, s11
    s_lshr_b32 s26, s2, 5
    s_cmp_lt_u32 s24, 4
    s_cbranch_scc1 L_kf_compute
    v_lshlrev_b32 v4, 4, v1
    s_sub_u32 s27, s24, 4
    s_mul_i32 s27, s27, 3
    s_mul_i32 s28, s25, 81920
    s_add_u32 s28, s28, 10485760
    s_mul_i32 s29, s26, 102400
    s_add_u32 s29, s29, 29728768
    s_lshl_b32 s34, s27, 10
    s_add_u32 s33, s27, 0
    s_lshr_b32 s35, s33, 2
    s_mul_i32 s35, s35, 36864
    s_add_u32 s35, s35, s28
    s_cmp_lt_u32 s33, 8
    s_cselect_b32 s35, s35, s29
    s_mov_b32 s43, 10240
    s_cmov_b32 s43, 4096
    s_add_u32 s40, s35, s34
    s_add_u32 s33, s27, 1
    s_lshr_b32 s35, s33, 2
    s_mul_i32 s35, s35, 36864
    s_add_u32 s35, s35, s28
    s_cmp_lt_u32 s33, 8
    s_cselect_b32 s35, s35, s29
    s_mov_b32 s44, 10240
    s_cmov_b32 s44, 4096
    s_add_u32 s41, s35, s34
    s_add_u32 s33, s27, 2
    s_lshr_b32 s35, s33, 2
    s_mul_i32 s35, s35, 36864
    s_add_u32 s35, s35, s28
    s_cmp_lt_u32 s33, 8
    s_cselect_b32 s35, s35, s29
    s_mov_b32 s45, 10240
    s_cmov_b32 s45, 4096
    s_add_u32 s42, s35, s34
    s_waitcnt lgkmcnt(0)
    s_mov_b32 s12, s8
    s_mov_b32 s13, s9
    s_add_u32 m0, s34, 0
    s_nop 0
    buffer_load_dwordx4 v4, s[12:15], s40 offen offset:0 lds
    buffer_load_dwordx4 v4, s[12:15], s41 offen offset:1024 lds
    buffer_load_dwordx4 v4, s[12:15], s42 offen offset:2048 lds
    s_add_u32 s40, s40, s43
    s_add_u32 s41, s41, s44
    s_add_u32 s42, s42, s45
    s_add_u32 m0, s34, 18432
    s_nop 0
    buffer_load_dwordx4 v4, s[12:15], s40 offen offset:0 lds
    buffer_load_dwordx4 v4, s[12:15], s41 offen offset:1024 lds
    buffer_load_dwordx4 v4, s[12:15], s42 offen offset:2048 lds
    s_add_u32 s40, s40, s43
    s_add_u32 s41, s41, s44
    s_add_u32 s42, s42, s45
    s_waitcnt vmcnt(3)
    s_barrier
    s_add_u32 m0, s34, 36864
    s_nop 0
    buffer_load_dwordx4 v4, s[12:15], s40 offen offset:0 lds
    buffer_load_dwordx4 v4, s[12:15], s41 offen offset:1024 lds
    buffer_load_dwordx4 v4, s[12:15], s42 offen offset:2048 lds
    s_add_u32 s40, s40, s43
    s_add_u32 s41, s41, s44
    s_add_u32 s42, s42, s45
    s_add_u32 m0, s34, 55296
    s_nop 0
    buffer_load_dwordx4 v4, s[12:15], s40 offen offset:0 lds
    buffer_load_dwordx4 v4, s[12:15], s41 offen offset:1024 lds
    buffer_load_dwordx4 v4, s[12:15], s42 offen offset:2048 lds
    s_add_u32 s40, s40, s43
    s_add_u32 s41, s41, s44
    s_add_u32 s42, s42, s45
    s_add_u32 m0, s34, 73728
    s_nop 0
    buffer_load_dwordx4 v4, s[12:15], s40 offen offset:0 lds
    buffer_load_dwordx4 v4, s[12:15], s41 offen offset:1024 lds
    buffer_load_dwordx4 v4, s[12:15], s42 offen offset:2048 lds
    s_add_u32 s40, s40, s43
    s_add_u32 s41, s41, s44
    s_add_u32 s42, s42, s45
    s_add_u32 s37, s34, 92160
    s_add_u32 s39, s34, 110592
    s_mov_b32 s38, 5
    s_branch L_p3_ld1
L_p3_ld:
    buffer_load_dwordx4 v4, s[12:15], s41 offen offset:1024 lds
    s_add_u32 s41, s41, s44
    s_add_u32 s37, s37, 18432
    s_cmp_lt_u32 s37, s39
    s_cselect_b32 s37, s37, s34
    buffer_load_dwordx4 v4, s[12:15], s42 offen offset:2048 lds
    s_add_u32 s42, s42, s45
L_p3_ld1:
    s_mov_b32 m0, s37
    s_waitcnt vmcnt(9)
    s_barrier
    buffer_load_dwordx4 v4, s[12:15], s40 offen offset:0 lds
    s_add_u32 s40, s40, s43
    s_add_u32 s38, s38, 1
    s_cmp_lt_u32 s38, 10
    s_cbranch_scc1 L_p3_ld
    buffer_load_dwordx4 v4, s[12:15], s41 offen offset:1024 lds
    buffer_load_dwordx4 v4, s[12:15], s42 offen offset:2048 lds
    s_sub_u32 s27, s24, 4
    s_lshl_b32 s33, s27, 7
    v_add_u32 v5, s33, v1
    v_add_u32 v6, 64, v5
    v_mul_u32_u24 v7, 6554, v5
    v_mul_u32_u24 v8, 6554, v6
    v_lshrrev_b32 v7, 16, v7
    v_lshrrev_b32 v8, 16, v8
    v_mul_u32_u24 v7, 1120, v7
    v_mul_u32_u24 v8, 1120, v8
    v_lshl_add_u32 v5, v5, 4, v7
    v_lshl_add_u32 v6, v6, 4, v8
    v_subrev_u32 v6, 1024, v6
    s_mul_i32 s33, s25, 81920
    s_mul_i32 s35, s26, 160
    s_add_u32 s33, s33, s35
    s_lshl_b32 s35, s27, 11
    s_add_u32 m0, s35, 110592
    s_mov_b32 s20, s4
    s_mov_b32 s21, s5
    s_cmp_lt_u32 s27, 5
    s_cselect_b32 s22, 2621440, 0
    s_mov_b32 s23, 0x20000
    buffer_load_dwordx4 v5, s[20:23], s33 offen lds
    buffer_load_dwordx4 v6, s[20:23], s33 offen offset:1024 lds
    s_lshr_b32 s52, s25, 1
    s_lshl_b32 s52, s52, 8
    s_add_u32 s52, s52, 30781440
    s_and_b32 s10, s2, 1
    s_lshl_b32 s10, s10, 3
    s_bfe_u32 s11, s2, 0x30003
    s_add_u32 s25, s10, s11
    s_bfe_u32 s10, s2, 0x20001
    s_lshl_b32 s10, s10, 2
    s_lshr_b32 s11, s2, 6
    s_add_u32 s44, s10, s11
    s_mul_i32 s26, s44, 112
    s_min_u32 s26, s26, 1616
    s_lshl_b32 s51, s25, 8
    s_add_u32 s51, s51, 30777344
    v_lshlrev_b32 v2, 4, v1
    s_lshl_b32 s28, s25, 2
    s_add_u32 s28, s28, s27
    s_and_b32 s29, s27, 1
    s_mul_i32 s30, s28, 40960
    s_add_u32 s30, s30, 13107200
    s_mul_i32 s31, s44, 286720
    s_mul_i32 s33, s27, 7168
    s_add_u32 s31, s31, s33
    s_add_u32 s31, s31, 22937600
    s_lshl_b32 s34, s27, 12
    s_lshr_b32 s33, s27, 1
    s_mul_i32 s35, s33, 14464
    s_mul_i32 s36, s29, 7168
    s_add_u32 s35, s35, s36
    s_add_u32 s35, s35, 16384
    s_add_u32 s36, s35, 4096
    v_add_u32 v3, 4096, v2
    s_waitcnt vmcnt(11)
    s_barrier
    s_waitcnt vmcnt(8)
    s_barrier
    s_waitcnt vmcnt(5)
    s_barrier
    s_waitcnt vmcnt(2)
    s_barrier
    s_waitcnt vmcnt(0)
    s_barrier
    s_barrier
    s_cmp_eq_u32 s24, 8
    s_cbranch_scc1 L_kf_w8
    s_cmp_eq_u32 s24, 9
    s_cbranch_scc1 L_kf_w9
    s_add_u32 m0, s35, 0
    s_nop 0
    buffer_load_dwordx4 v2, s[12:15], s31 offen offset:0 lds
    buffer_load_dwordx4 v2, s[12:15], s31 offen offset:1024 lds
    buffer_load_dwordx4 v2, s[12:15], s31 offen offset:2048 lds
    buffer_load_dwordx4 v2, s[12:15], s31 offen offset:3072 lds
    s_add_u32 m0, s36, 0
    s_nop 0
    buffer_load_dwordx4 v3, s[12:15], s31 offen offset:0 lds
    buffer_load_dwordx4 v3, s[12:15], s31 offen offset:1024 lds
    buffer_load_dwordx4 v3, s[12:15], s31 offen offset:2048 lds
    s_add_u32 s31, s31, 28672
    s_add_u32 m0, s35, 45312
    s_nop 0
    buffer_load_dwordx4 v2, s[12:15], s31 offen offset:0 lds
    buffer_load_dwordx4 v2, s[12:15], s31 offen offset:1024 lds
    buffer_load_dwordx4 v2, s[12:15], s31 offen offset:2048 lds
    buffer_load_dwordx4 v2, s[12:15], s31 offen offset:3072 lds
    s_add_u32 m0, s36, 45312
    s_nop 0
    buffer_load_dwordx4 v3, s[12:15], s31 offen offset:0 lds
    buffer_load_dwordx4 v3, s[12:15], s31 offen offset:1024 lds
    buffer_load_dwordx4 v3, s[12:15], s31 offen offset:2048 lds
    s_add_u32 s31, s31, 28672
    s_barrier
    s_add_u32 m0, s34, 0
    s_nop 0
    buffer_load_dwordx4 v2, s[12:15], s30 offen offset:0 sc1 lds
    buffer_load_dwordx4 v2, s[12:15], s30 offen offset:1024 sc1 lds
    buffer_load_dwordx4 v2, s[12:15], s30 offen offset:2048 sc1 lds
    buffer_load_dwordx4 v2, s[12:15], s30 offen offset:3072 sc1 lds
    s_add_u32 s30, s30, 4096
    s_add_u32 m0, s34, 45312
    s_nop 0
    buffer_load_dwordx4 v2, s[12:15], s30 offen offset:0 sc1 lds
    buffer_load_dwordx4 v2, s[12:15], s30 offen offset:1024 sc1 lds
    buffer_load_dwordx4 v2, s[12:15], s30 offen offset:2048 sc1 lds
    buffer_load_dwordx4 v2, s[12:15], s30 offen offset:3072 sc1 lds
    s_add_u32 s30, s30, 4096
    s_waitcnt vmcnt(4)
    s_barrier
    s_add_u32 m0, s34, 90624
    s_nop 0
    buffer_load_dwordx4 v2, s[12:15], s30 offen offset:0 sc1 lds
    buffer_load_dwordx4 v2, s[12:15], s30 offen offset:1024 sc1 lds
    buffer_load_dwordx4 v2, s[12:15], s30 offen offset:2048 sc1 lds
    buffer_load_dwordx4 v2, s[12:15], s30 offen offset:3072 sc1 lds
    s_add_u32 s30, s30, 4096
    s_add_u32 m0, s35, 90624
    s_nop 0
    buffer_load_dwordx4 v2, s[12:15], s31 offen offset:0 lds
    buffer_load_dwordx4 v2, s[12:15], s31 offen offset:1024 lds
    buffer_load_dwordx4 v2, s[12:15], s31 offen offset:2048 lds
    buffer_load_dwordx4 v2, s[12:15], s31 offen offset:3072 lds
    s_add_u32 m0, s36, 90624
    s_nop 0
    buffer_load_dwordx4 v3, s[12:15], s31 offen offset:0 lds
    buffer_load_dwordx4 v3, s[12:15], s31 offen offset:1024 lds
    buffer_load_dwordx4 v3, s[12:15], s31 offen offset:2048 lds
    s_add_u32 s31, s31, 28672
    s_waitcnt vmcnt(11)
    s_mov_b32 s37, 0
    s_mov_b32 s38, 1
    s_add_u32 m0, s34, s37
    s_branch L_p4_ld3
L_p4_ld:
    buffer_load_dwordx4 v2, s[12:15], s30 offen offset:1024 sc1 lds
    buffer_load_dwordx4 v2, s[12:15], s30 offen offset:2048 sc1 lds
    buffer_load_dwordx4 v2, s[12:15], s30 offen offset:3072 sc1 lds
    s_add_u32 s30, s30, 4096
    s_add_u32 m0, s35, s37
    s_nop 0
    buffer_load_dwordx4 v2, s[12:15], s31 offen offset:0 lds
    buffer_load_dwordx4 v2, s[12:15], s31 offen offset:1024 lds
    buffer_load_dwordx4 v2, s[12:15], s31 offen offset:2048 lds
    buffer_load_dwordx4 v2, s[12:15], s31 offen offset:3072 lds
    s_add_u32 m0, s36, s37
    s_nop 0
    buffer_load_dwordx4 v3, s[12:15], s31 offen offset:0 lds
    buffer_load_dwordx4 v3, s[12:15], s31 offen offset:1024 lds
    buffer_load_dwordx4 v3, s[12:15], s31 offen offset:2048 lds
    s_add_u32 s31, s31, 28672
    s_add_u32 s37, s37, 45312
    s_cmp_lt_u32 s37, 135936
    s_cselect_b32 s37, s37, 0
    s_cmp_eq_u32 s38, 8
    s_cbranch_scc1 L_p4_ld2
    s_add_u32 m0, s34, s37
    s_waitcnt vmcnt(11)
L_p4_ld3:
    s_barrier
    buffer_load_dwordx4 v2, s[12:15], s30 offen offset:0 sc1 lds
    s_add_u32 s38, s38, 1
    s_branch L_p4_ld
L_p4_ld2:
    s_waitcnt vmcnt(11)
    s_barrier
    s_waitcnt vmcnt(0)
    s_barrier
    s_barrier
    s_branch L_kf_p5ld
L_kf_w8:
    v_lshlrev_b32 v6, 2, v1
    s_mov_b32 s33, 0x40000
L_poll3:
    buffer_load_dword v8, v6, s[12:15], s51 offen sc1
    s_sub_u32 s33, s33, 1
    s_cmp_eq_u32 s33, 0
    s_cbranch_scc1 L_polldone3
    s_waitcnt vmcnt(0)
    v_cmp_eq_u32 vcc, 0, v8
    s_cbranch_vccnz L_poll3
L_polldone3:
    s_barrier
    s_lshl_b32 s33, s25, 10
    s_add_u32 s33, s33, 15728640
    buffer_load_dwordx4 v[16:19], v2, s[12:15], s33 offen sc1
    s_add_u32 s33, s33, 16384
    buffer_load_dwordx4 v[20:23], v2, s[12:15], s33 offen sc1
    s_add_u32 s33, s33, 16384
    buffer_load_dwordx4 v[24:27], v2, s[12:15], s33 offen sc1
    s_add_u32 s33, s33, 16384
    buffer_load_dwordx4 v[28:31], v2, s[12:15], s33 offen sc1
    s_add_u32 s33, s33, 16384
    buffer_load_dwordx4 v[32:35], v2, s[12:15], s33 offen sc1
    s_add_u32 s33, s33, 16384
    buffer_load_dwordx4 v[36:39], v2, s[12:15], s33 offen sc1
    s_add_u32 s33, s33, 16384
    buffer_load_dwordx4 v[40:43], v2, s[12:15], s33 offen sc1
    s_add_u32 s33, s33, 16384
    buffer_load_dwordx4 v[44:47], v2, s[12:15], s33 offen sc1
    v_cmp_lt_u32 vcc, 27, v1
    v_mov_b32 v6, 6464
    s_nop 0
    v_cndmask_b32 v5, 0, v6, vcc
    v_add_u32 v5, v5, v2
    s_lshl_b32 s33, s26, 2
    s_add_u32 s33, s33, 30556160
    buffer_load_dwordx4 v[48:51], v5, s[12:15], s33 offen
    s_add_u32 s33, s33, 13824
    buffer_load_dwordx4 v[52:55], v5, s[12:15], s33 offen
    s_add_u32 s33, s33, 13824
    buffer_load_dwordx4 v[56:59], v5, s[12:15], s33 offen
    s_add_u32 s33, s33, 13824
    buffer_load_dwordx4 v[60:63], v5, s[12:15], s33 offen
    s_add_u32 s33, s33, 13824
    buffer_load_dwordx4 v[64:67], v5, s[12:15], s33 offen
    s_add_u32 s33, s33, 13824
    buffer_load_dwordx4 v[68:71], v5, s[12:15], s33 offen
    s_add_u32 s33, s33, 13824
    buffer_load_dwordx4 v[72:75], v5, s[12:15], s33 offen
    s_add_u32 s33, s33, 13824
    buffer_load_dwordx4 v[76:79], v5, s[12:15], s33 offen
    s_add_u32 s33, s33, 13824
    buffer_load_dwordx4 v[80:83], v5, s[12:15], s33 offen
    s_add_u32 s33, s33, 13824
    buffer_load_dwordx4 v[84:87], v5, s[12:15], s33 offen
    s_add_u32 s33, s33, 13824
    buffer_load_dwordx4 v[88:91], v5, s[12:15], s33 offen
    s_add_u32 s33, s33, 13824
    buffer_load_dwordx4 v[92:95], v5, s[12:15], s33 offen
    s_add_u32 s33, s33, 13824
    buffer_load_dwordx4 v[96:99], v5, s[12:15], s33 offen
    s_add_u32 s33, s33, 13824
    buffer_load_dwordx4 v[100:103], v5, s[12:15], s33 offen
    s_add_u32 s33, s33, 13824
    buffer_load_dwordx4 v[104:107], v5, s[12:15], s33 offen
    s_add_u32 s33, s33, 13824
    buffer_load_dwordx4 v[108:111], v5, s[12:15], s33 offen
    s_barrier
    s_barrier
    s_barrier
    s_waitcnt vmcnt(16)
    v_add_f32 v16, v16, v32
    v_add_f32 v17, v17, v33
    v_add_f32 v18, v18, v34
    v_add_f32 v19, v19, v35
    v_add_f32 v20, v20, v36
    v_add_f32 v21, v21, v37
    v_add_f32 v22, v22, v38
    v_add_f32 v23, v23, v39
    v_add_f32 v24, v24, v40
    v_add_f32 v25, v25, v41
    v_add_f32 v26, v26, v42
    v_add_f32 v27, v27, v43
    v_add_f32 v28, v28, v44
    v_add_f32 v29, v29, v45
    v_add_f32 v30, v30, v46
    v_add_f32 v31, v31, v47
    v_add_f32 v16, v16, v24
    v_add_f32 v17, v17, v25
    v_add_f32 v18, v18, v26
    v_add_f32 v19, v19, v27
    v_add_f32 v20, v20, v28
    v_add_f32 v21, v21, v29
    v_add_f32 v22, v22, v30
    v_add_f32 v23, v23, v31
    v_add_f32 v16, v16, v20
    v_add_f32 v17, v17, v21
    v_add_f32 v18, v18, v22
    v_add_f32 v19, v19, v23
    v_lshlrev_b32 v6, 5, v1
    v_add_u32 v6, 136960, v6
    v_mul_f32 v8, 0xbacccccd, v16
    v_mul_f32 v17, 0x3acccccd, v17
    v_fma_f32 v17, -v8, v8, v17
    v_max_f32 v17, 0, v17
    v_add_f32 v11, 0x3727c5ac, v17
    v_rsq_f32 v17, v11
    s_nop 0
    v_mul_f32 v9, 0xc0135761, v17
    v_mul_f32 v16, v17, v17
    v_mul_f32 v10, 0x3d372713, v9
    v_mul_f32 v10, v10, v16
    ds_write_b128 v6, v[8:11] offset:0
    v_mul_f32 v24, 0xbacccccd, v18
    v_mul_f32 v19, 0x3acccccd, v19
    v_fma_f32 v19, -v24, v24, v19
    v_max_f32 v19, 0, v19
    v_add_f32 v27, 0x3727c5ac, v19
    v_rsq_f32 v19, v27
    s_nop 0
    v_mul_f32 v25, 0xc0135761, v19
    v_mul_f32 v18, v19, v19
    v_mul_f32 v26, 0x3d372713, v25
    v_mul_f32 v26, v26, v18
    ds_write_b128 v6, v[24:27] offset:16
    s_barrier
    s_waitcnt vmcnt(0)
    v_add_f32 v48, v48, v80
    v_add_f32 v49, v49, v81
    v_add_f32 v50, v50, v82
    v_add_f32 v51, v51, v83
    v_add_f32 v52, v52, v84
    v_add_f32 v53, v53, v85
    v_add_f32 v54, v54, v86
    v_add_f32 v55, v55, v87
    v_add_f32 v56, v56, v88
    v_add_f32 v57, v57, v89
    v_add_f32 v58, v58, v90
    v_add_f32 v59, v59, v91
    v_add_f32 v60, v60, v92
    v_add_f32 v61, v61, v93
    v_add_f32 v62, v62, v94
    v_add_f32 v63, v63, v95
    v_add_f32 v64, v64, v96
    v_add_f32 v65, v65, v97
    v_add_f32 v66, v66, v98
    v_add_f32 v67, v67, v99
    v_add_f32 v68, v68, v100
    v_add_f32 v69, v69, v101
    v_add_f32 v70, v70, v102
    v_add_f32 v71, v71, v103
    v_add_f32 v72, v72, v104
    v_add_f32 v73, v73, v105
    v_add_f32 v74, v74, v106
    v_add_f32 v75, v75, v107
    v_add_f32 v76, v76, v108
    v_add_f32 v77, v77, v109
    v_add_f32 v78, v78, v110
    v_add_f32 v79, v79, v111
    v_add_f32 v48, v48, v64
    v_add_f32 v49, v49, v65
    v_add_f32 v50, v50, v66
    v_add_f32 v51, v51, v67
    v_add_f32 v52, v52, v68
    v_add_f32 v53, v53, v69
    v_add_f32 v54, v54, v70
    v_add_f32 v55, v55, v71
    v_add_f32 v56, v56, v72
    v_add_f32 v57, v57, v73
    v_add_f32 v58, v58, v74
    v_add_f32 v59, v59, v75
    v_add_f32 v60, v60, v76
    v_add_f32 v61, v61, v77
    v_add_f32 v62, v62, v78
    v_add_f32 v63, v63, v79
    v_add_f32 v48, v48, v56
    v_add_f32 v49, v49, v57
    v_add_f32 v50, v50, v58
    v_add_f32 v51, v51, v59
    v_add_f32 v52, v52, v60
    v_add_f32 v53, v53, v61
    v_add_f32 v54, v54, v62
    v_add_f32 v55, v55, v63
    v_add_f32 v48, v48, v52
    v_add_f32 v49, v49, v53
    v_add_f32 v50, v50, v54
    v_add_f32 v51, v51, v55
    v_add_u32 v6, 135936, v2
    s_mov_b32 exec_hi, 0x00ffffff
    ds_write_b128 v6, v[48:51]
    s_mov_b32 exec_hi, -1
    s_waitcnt lgkmcnt(0)
    s_barrier
    s_barrier
    s_barrier
    s_barrier
    s_barrier
    s_barrier
    s_barrier
    s_branch L_kf_p5ld
L_kf_w9:
    s_and_b32 s40, s2, 1
    s_mul_i32 s40, s40, 1105920
    s_lshr_b32 s41, s2, 3
    s_mul_i32 s41, s41, 34560
    s_add_u32 s40, s40, s41
    s_add_u32 s40, s40, 27525120
    s_mov_b32 s38, 0
    s_barrier
L_kf_w9l:
    s_barrier
    buffer_load_dwordx4 v[12:15], v2, s[12:15], s40 offen offset:0
    buffer_load_dwordx4 v[12:15], v2, s[12:15], s40 offen offset:1024
    buffer_load_dwordx4 v[12:15], v2, s[12:15], s40 offen offset:2048
    buffer_load_dwordx4 v[12:15], v2, s[12:15], s40 offen offset:3072
    s_add_u32 s40, s40, 4096
    s_add_u32 s38, s38, 1
    s_cmp_lt_u32 s38, 9
    s_cbranch_scc1 L_kf_w9l
    s_barrier
    s_barrier
L_kf_p5ld:
    s_and_b32 s10, s2, 7
    s_lshl_b32 s10, s10, 2
    s_bfe_u32 s11, s2, 0x20003
    s_add_u32 s25, s10, s11
    s_lshr_b32 s26, s2, 5
    v_lshlrev_b32 v4, 4, v1
    s_sub_u32 s27, s24, 4
    s_mul_i32 s27, s27, 3
    s_mul_i32 s28, s25, 221184
    s_add_u32 s28, s28, 15859712
    s_mul_i32 s29, s26, 276480
    s_add_u32 s29, s29, 27516928
    s_lshl_b32 s34, s27, 10
    s_add_u32 s33, s27, 0
    s_lshr_b32 s35, s33, 2
    s_mul_i32 s35, s35, 106496
    s_add_u32 s35, s35, s28
    s_cmp_lt_u32 s33, 8
    s_cselect_b32 s35, s35, s29
    s_mov_b32 s43, 10240
    s_cmov_b32 s43, 4096
    s_add_u32 s40, s35, s34
    s_add_u32 s33, s27, 1
    s_lshr_b32 s35, s33, 2
    s_mul_i32 s35, s35, 106496
    s_add_u32 s35, s35, s28
    s_cmp_lt_u32 s33, 8
    s_cselect_b32 s35, s35, s29
    s_mov_b32 s44, 10240
    s_cmov_b32 s44, 4096
    s_add_u32 s41, s35, s34
    s_add_u32 s33, s27, 2
    s_lshr_b32 s35, s33, 2
    s_mul_i32 s35, s35, 106496
    s_add_u32 s35, s35, s28
    s_cmp_lt_u32 s33, 8
    s_cselect_b32 s35, s35, s29
    s_mov_b32 s45, 10240
    s_cmov_b32 s45, 4096
    s_add_u32 s42, s35, s34
    s_waitcnt vmcnt(0)
    s_barrier
    s_cmp_lt_u32 s24, 7
    s_cbranch_scc1 L_kf_p5tok
    s_add_u32 m0, s34, 0
    s_nop 0
    buffer_load_dwordx4 v4, s[12:15], s40 offen offset:0 sc1 lds
    buffer_load_dwordx4 v4, s[12:15], s41 offen offset:1024 sc1 lds
    buffer_load_dwordx4 v4, s[12:15], s42 offen offset:2048 sc1 lds
    s_add_u32 s40, s40, s43
    s_add_u32 s41, s41, s44
    s_add_u32 s42, s42, s45
    s_add_u32 m0, s34, 18432
    s_nop 0
    buffer_load_dwordx4 v4, s[12:15], s40 offen offset:0 sc1 lds
    buffer_load_dwordx4 v4, s[12:15], s41 offen offset:1024 sc1 lds
    buffer_load_dwordx4 v4, s[12:15], s42 offen offset:2048 sc1 lds
    s_add_u32 s40, s40, s43
    s_add_u32 s41, s41, s44
    s_add_u32 s42, s42, s45
    s_add_u32 m0, s34, 36864
    s_nop 0
    buffer_load_dwordx4 v4, s[12:15], s40 offen offset:0 sc1 lds
    buffer_load_dwordx4 v4, s[12:15], s41 offen offset:1024 sc1 lds
    buffer_load_dwordx4 v4, s[12:15], s42 offen offset:2048 sc1 lds
    s_add_u32 s40, s40, s43
    s_add_u32 s41, s41, s44
    s_add_u32 s42, s42, s45
    s_add_u32 m0, s34, 55296
    s_nop 0
    buffer_load_dwordx4 v4, s[12:15], s40 offen offset:0 sc1 lds
    buffer_load_dwordx4 v4, s[12:15], s41 offen offset:1024 sc1 lds
    buffer_load_dwordx4 v4, s[12:15], s42 offen offset:2048 sc1 lds
    s_add_u32 s40, s40, s43
    s_add_u32 s41, s41, s44
    s_add_u32 s42, s42, s45
    s_barrier
    s_waitcnt vmcnt(9)
    s_barrier
    s_add_u32 m0, s34, 73728
    s_nop 0
    buffer_load_dwordx4 v4, s[12:15], s40 offen offset:0 sc1 lds
    buffer_load_dwordx4 v4, s[12:15], s41 offen offset:1024 sc1 lds
    buffer_load_dwordx4 v4, s[12:15], s42 offen offset:2048 sc1 lds
    s_add_u32 s40, s40, s43
    s_add_u32 s41, s41, s44
    s_add_u32 s42, s42, s45
    s_branch L_kf_p5loop
L_kf_p5tok:
    s_cmp_lg_u32 s24, 4
    s_cbranch_scc1 L_kf_p5np
    v_lshlrev_b32 v6, 2, v1
    s_mov_b32 s33, 0x40000
L_poll4:
    buffer_load_dword v8, v6, s[12:15], s52 offen sc1
    s_sub_u32 s33, s33, 1
    s_cmp_eq_u32 s33, 0
    s_cbranch_scc1 L_polldone4
    s_waitcnt vmcnt(0)
    v_cmp_eq_u32 vcc, 0, v8
    s_cbranch_vccnz L_poll4
L_polldone4:
L_kf_p5np:
    s_barrier
    s_add_u32 m0, s34, 0
    s_nop 0
    buffer_load_dwordx4 v4, s[12:15], s40 offen offset:0 sc1 lds
    buffer_load_dwordx4 v4, s[12:15], s41 offen offset:1024 sc1 lds
    buffer_load_dwordx4 v4, s[12:15], s42 offen offset:2048 sc1 lds
    s_add_u32 s40, s40, s43
    s_add_u32 s41, s41, s44
    s_add_u32 s42, s42, s45
    s_add_u32 m0, s34, 18432
    s_nop 0
    buffer_load_dwordx4 v4, s[12:15], s40 offen offset:0 sc1 lds
    buffer_load_dwordx4 v4, s[12:15], s41 offen offset:1024 sc1 lds
    buffer_load_dwordx4 v4, s[12:15], s42 offen offset:2048 sc1 lds
    s_add_u32 s40, s40, s43
    s_add_u32 s41, s41, s44
    s_add_u32 s42, s42, s45
    s_waitcnt vmcnt(3)
    s_barrier
    s_add_u32 m0, s34, 36864
    s_nop 0
    buffer_load_dwordx4 v4, s[12:15], s40 offen offset:0 sc1 lds
    buffer_load_dwordx4 v4, s[12:15], s41 offen offset:1024 sc1 lds
    buffer_load_dwordx4 v4, s[12:15], s42 offen offset:2048 sc1 lds
    s_add_u32 s40, s40, s43
    s_add_u32 s41, s41, s44
    s_add_u32 s42, s42, s45
    s_add_u32 m0, s34, 55296
    s_nop 0
    buffer_load_dwordx4 v4, s[12:15], s40 offen offset:0 sc1 lds
    buffer_load_dwordx4 v4, s[12:15], s41 offen offset:1024 sc1 lds
    buffer_load_dwordx4 v4, s[12:15], s42 offen offset:2048 sc1 lds
    s_add_u32 s40, s40, s43
    s_add_u32 s41, s41, s44
    s_add_u32 s42, s42, s45
    s_add_u32 m0, s34, 73728
    s_nop 0
    buffer_load_dwordx4 v4, s[12:15], s40 offen offset:0 sc1 lds
    buffer_load_dwordx4 v4, s[12:15], s41 offen offset:1024 sc1 lds
    buffer_load_dwordx4 v4, s[12:15], s42 offen offset:2048 sc1 lds
    s_add_u32 s40, s40, s43
    s_add_u32 s41, s41, s44
    s_add_u32 s42, s42, s45
L_kf_p5loop:
    s_add_u32 s37, s34, 92160
    s_add_u32 s39, s34, 110592
    s_mov_b32 s38, 5
    s_branch L_p5_ld1
L_p5_ld:
    buffer_load_dwordx4 v4, s[12:15], s41 offen offset:1024 sc1 lds
    s_add_u32 s41, s41, s44
    s_add_u32 s37, s37, 18432
    s_cmp_lt_u32 s37, s39
    s_cselect_b32 s37, s37, s34
    buffer_load_dwordx4 v4, s[12:15], s42 offen offset:2048 sc1 lds
    s_add_u32 s42, s42, s45
L_p5_ld1:
    s_mov_b32 m0, s37
    s_waitcnt vmcnt(9)
    s_barrier
    buffer_load_dwordx4 v4, s[12:15], s40 offen offset:0 sc1 lds
    s_add_u32 s40, s40, s43
    s_add_u32 s38, s38, 1
    s_cmp_lt_u32 s38, 27
    s_cbranch_scc1 L_p5_ld
    buffer_load_dwordx4 v4, s[12:15], s41 offen offset:1024 sc1 lds
    buffer_load_dwordx4 v4, s[12:15], s42 offen offset:2048 sc1 lds
    s_waitcnt vmcnt(9)
    s_barrier
    s_waitcnt vmcnt(6)
    s_barrier
    s_waitcnt vmcnt(3)
    s_barrier
    s_waitcnt vmcnt(0)
    s_barrier
    s_endpgm
L_kf_compute:
    v_and_b32 v2, 15, v1
    v_lshrrev_b32 v3, 4, v1
    s_lshr_b32 s33, s24, 1
    s_lshl_b32 s28, s25, 1
    s_add_u32 s28, s28, s33
    s_and_b32 s29, s24, 1
    s_lshl_b32 s33, s25, 6
    s_lshl_b32 s34, s24, 4
    s_add_u32 s43, s33, s34
    v_lshlrev_b32 v8, 9, v3
    v_lshl_add_u32 v8, v2, 4, v8
    s_lshr_b32 s33, s24, 1
    s_lshl_b32 s33, s33, 12
    s_lshl_b32 s34, s29, 8
    s_add_u32 s33, s33, s34
    v_add_u32 v8, s33, v8
    v_lshrrev_b32 v9, 1, v3
    v_lshlrev_b32 v9, 4, v9
    v_and_b32 v10, 1, v3
    v_lshl_add_u32 v9, v10, 2, v9
    v_bfe_u32 v10, v1, 2, 2
    v_add_u32 v9, v9, v10
    v_mul_u32_u24 v9, 160, v9
    v_and_b32 v10, 3, v1
    v_lshl_add_u32 v9, v10, 3, v9
    v_add_u32 v9, 8192, v9
    v_mov_b32 v10, v8
    v_mov_b32 v11, v9
    s_mov_b32 s37, 0
    s_mov_b32 s38, 0
    s_mul_i32 s33, s24, 2560
    s_add_u32 s33, s33, 153600
    v_lshrrev_b32 v5, 1, v3
    v_lshlrev_b32 v5, 8, v5
    v_lshl_add_u32 v5, v2, 4, v5
    v_and_b32 v6, 1, v3
    v_lshl_add_u32 v5, v6, 3, v5
    v_add_u32 v5, s33, v5
    v_lshl_add_u32 v140, v1, 4, s33
    v_mov_b32 v60, 0
    v_mov_b32 v61, 0
    v_mov_b32 v62, 0
    v_mov_b32 v63, 0
    v_mov_b32 v64, 0
    v_mov_b32 v65, 0
    v_mov_b32 v66, 0
    v_mov_b32 v67, 0
    v_mov_b32 v68, 0
    v_mov_b32 v69, 0
    v_mov_b32 v70, 0
    v_mov_b32 v71, 0
    v_mov_b32 v72, 0
    v_mov_b32 v73, 0
    v_mov_b32 v74, 0
    v_mov_b32 v75, 0
    v_mov_b32 v76, 0
    v_mov_b32 v77, 0
    v_mov_b32 v78, 0
    v_mov_b32 v79, 0
    v_lshlrev_b32 v4, 9, v3
    v_lshl_add_u32 v4, v2, 4, v4
    s_lshl_b32 s33, s29, 8
    v_add_u32 v4, s33, v4
    s_mul_i32 s40, s28, 40960
    s_mul_i32 s33, s26, 5120
    s_add_u32 s40, s40, s33
    s_add_u32 s40, s40, 13107200
    s_add_u32 s42, s40, 4096
    v_lshlrev_b32 v6, 3, v2
    s_mul_i32 s33, s24, 2560
    s_add_u32 s33, s33, 110592
    v_mul_u32_u24 v7, 160, v2
    v_lshl_add_u32 v7, v3, 3, v7
    v_add_u32 v7, s33, v7
    s_lshl_b32 s44, s26, 14
    s_lshl_b32 s33, s43, 3
    s_add_u32 s44, s44, s33
    s_add_u32 s44, s44, 15728640
    s_lshr_b32 s50, s25, 1
    s_lshl_b32 s50, s50, 8
    s_and_b32 s33, s25, 1
    s_lshl_b32 s33, s33, 3
    s_add_u32 s33, s33, s26
    s_lshl_b32 s33, s33, 2
    s_add_u32 s33, s33, s24
    s_lshl_b32 s33, s33, 2
    s_add_u32 s50, s50, s33
    s_add_u32 s50, s50, 30777344
    s_waitcnt lgkmcnt(0)
    s_mov_b32 s12, s8
    s_mov_b32 s13, s9
    s_barrier
    ds_read_b128 v[12:15], v10 offset:0
    ds_read_b64_tr_b16 v[16:17], v11 offset:0
    ds_read_b64_tr_b16 v[18:19], v11 offset:1280
    ds_read_b64_tr_b16 v[20:21], v11 offset:32
    ds_read_b64_tr_b16 v[22:23], v11 offset:1312
    ds_read_b64_tr_b16 v[24:25], v11 offset:64
    ds_read_b64_tr_b16 v[26:27], v11 offset:1344
    ds_read_b64_tr_b16 v[28:29], v11 offset:96
    ds_read_b64_tr_b16 v[30:31], v11 offset:1376
    ds_read_b64_tr_b16 v[32:33], v11 offset:128
    ds_read_b64_tr_b16 v[34:35], v11 offset:1408
    ds_read_b128 v[36:39], v10 offset:2048
    ds_read_b64_tr_b16 v[40:41], v11 offset:5120
    ds_read_b64_tr_b16 v[42:43], v11 offset:6400
    ds_read_b64_tr_b16 v[44:45], v11 offset:5152
    ds_read_b64_tr_b16 v[46:47], v11 offset:6432
    ds_read_b64_tr_b16 v[48:49], v11 offset:5184
    ds_read_b64_tr_b16 v[50:51], v11 offset:6464
    ds_read_b64_tr_b16 v[52:53], v11 offset:5216
    ds_read_b64_tr_b16 v[54:55], v11 offset:6496
    ds_read_b64_tr_b16 v[56:57], v11 offset:5248
    ds_read_b64_tr_b16 v[58:59], v11 offset:6528
    s_add_u32 s37, s37, 18432
    s_cmp_lt_u32 s37, 110592
    s_cselect_b32 s37, s37, 0
    v_add_u32 v10, s37, v8
    v_add_u32 v11, s37, v9
.p2align 6
L_p3_loop:
    s_waitcnt lgkmcnt(0)
    s_barrier
    ds_read_b128 v[92:95], v10 offset:0
    ds_read_b64_tr_b16 v[96:97], v11 offset:0
    ds_read_b64_tr_b16 v[98:99], v11 offset:1280
    v_mfma_f32_16x16x32_bf16 v[60:63], v[16:19], v[12:15], v[60:63]
    ds_read_b64_tr_b16 v[100:101], v11 offset:32
    ds_read_b64_tr_b16 v[102:103], v11 offset:1312
    ds_read_b64_tr_b16 v[104:105], v11 offset:64
    v_mfma_f32_16x16x32_bf16 v[64:67], v[20:23], v[12:15], v[64:67]
    ds_read_b64_tr_b16 v[106:107], v11 offset:1344
    ds_read_b64_tr_b16 v[108:109], v11 offset:96
    ds_read_b64_tr_b16 v[110:111], v11 offset:1376
    v_mfma_f32_16x16x32_bf16 v[68:71], v[24:27], v[12:15], v[68:71]
    ds_read_b64_tr_b16 v[112:113], v11 offset:128
    ds_read_b64_tr_b16 v[114:115], v11 offset:1408
    ds_read_b128 v[116:119], v10 offset:2048
    v_mfma_f32_16x16x32_bf16 v[72:75], v[28:31], v[12:15], v[72:75]
    ds_read_b64_tr_b16 v[120:121], v11 offset:5120
    ds_read_b64_tr_b16 v[122:123], v11 offset:6400
    v_mfma_f32_16x16x32_bf16 v[76:79], v[32:35], v[12:15], v[76:79]
    ds_read_b64_tr_b16 v[124:125], v11 offset:5152
    ds_read_b64_tr_b16 v[126:127], v11 offset:6432
    v_mfma_f32_16x16x32_bf16 v[60:63], v[40:43], v[36:39], v[60:63]
    ds_read_b64_tr_b16 v[128:129], v11 offset:5184
    ds_read_b64_tr_b16 v[130:131], v11 offset:6464
    v_mfma_f32_16x16x32_bf16 v[64:67], v[44:47], v[36:39], v[64:67]
    ds_read_b64_tr_b16 v[132:133], v11 offset:5216
    ds_read_b64_tr_b16 v[134:135], v11 offset:6496
    v_mfma_f32_16x16x32_bf16 v[68:71], v[48:51], v[36:39], v[68:71]
    ds_read_b64_tr_b16 v[136:137], v11 offset:5248
    ds_read_b64_tr_b16 v[138:139], v11 offset:6528
    v_mfma_f32_16x16x32_bf16 v[72:75], v[52:55], v[36:39], v[72:75]
    v_mfma_f32_16x16x32_bf16 v[76:79], v[56:59], v[36:39], v[76:79]
    s_add_u32 s37, s37, 18432
    s_cmp_lt_u32 s37, 110592
    s_cselect_b32 s37, s37, 0
    v_add_u32 v10, s37, v8
    v_add_u32 v11, s37, v9
    s_add_u32 s38, s38, 1
    s_cmp_lt_u32 s38, 10
    s_waitcnt lgkmcnt(0)
    s_barrier
    ds_read_b128 v[12:15], v10 offset:0
    ds_read_b64_tr_b16 v[16:17], v11 offset:0
    ds_read_b64_tr_b16 v[18:19], v11 offset:1280
    v_mfma_f32_16x16x32_bf16 v[60:63], v[96:99], v[92:95], v[60:63]
    ds_read_b64_tr_b16 v[20:21], v11 offset:32
    ds_read_b64_tr_b16 v[22:23], v11 offset:1312
    ds_read_b64_tr_b16 v[24:25], v11 offset:64
    v_mfma_f32_16x16x32_bf16 v[64:67], v[100:103], v[92:95], v[64:67]
    ds_read_b64_tr_b16 v[26:27], v11 offset:1344
    ds_read_b64_tr_b16 v[28:29], v11 offset:96
    ds_read_b64_tr_b16 v[30:31], v11 offset:1376
    v_mfma_f32_16x16x32_bf16 v[68:71], v[104:107], v[92:95], v[68:71]
    ds_read_b64_tr_b16 v[32:33], v11 offset:128
    ds_read_b64_tr_b16 v[34:35], v11 offset:1408
    ds_read_b128 v[36:39], v10 offset:2048
    v_mfma_f32_16x16x32_bf16 v[72:75], v[108:111], v[92:95], v[72:75]
    ds_read_b64_tr_b16 v[40:41], v11 offset:5120
    ds_read_b64_tr_b16 v[42:43], v11 offset:6400
    v_mfma_f32_16x16x32_bf16 v[76:79], v[112:115], v[92:95], v[76:79]
    ds_read_b64_tr_b16 v[44:45], v11 offset:5152
    ds_read_b64_tr_b16 v[46:47], v11 offset:6432
    v_mfma_f32_16x16x32_bf16 v[60:63], v[120:123], v[116:119], v[60:63]
    ds_read_b64_tr_b16 v[48:49], v11 offset:5184
    ds_read_b64_tr_b16 v[50:51], v11 offset:6464
    v_mfma_f32_16x16x32_bf16 v[64:67], v[124:127], v[116:119], v[64:67]
    ds_read_b64_tr_b16 v[52:53], v11 offset:5216
    ds_read_b64_tr_b16 v[54:55], v11 offset:6496
    v_mfma_f32_16x16x32_bf16 v[68:71], v[128:131], v[116:119], v[68:71]
    ds_read_b64_tr_b16 v[56:57], v11 offset:5248
    ds_read_b64_tr_b16 v[58:59], v11 offset:6528
    v_mfma_f32_16x16x32_bf16 v[72:75], v[132:135], v[116:119], v[72:75]
    v_mfma_f32_16x16x32_bf16 v[76:79], v[136:139], v[116:119], v[76:79]
    s_add_u32 s37, s37, 18432
    s_cmp_lt_u32 s37, 110592
    s_cselect_b32 s37, s37, 0
    v_add_u32 v10, s37, v8
    v_add_u32 v11, s37, v9
    s_add_u32 s38, s38, 1
    s_cmp_lt_u32 s38, 10
    s_cbranch_scc1 L_p3_loop
L_p3_done:
    ds_read_b64 v[80:81], v7 offset:0
    ds_read_b64 v[82:83], v7 offset:32
    ds_read_b64 v[84:85], v7 offset:64
    ds_read_b64 v[86:87], v7 offset:96
    ds_read_b64 v[88:89], v7 offset:128
    s_nop 2
    s_waitcnt lgkmcnt(0)
    v_lshlrev_b32 v12, 16, v80
    v_and_b32 v13, 0xffff0000, v80
    v_pk_add_f32 v[60:61], v[60:61], v[12:13]
    v_lshlrev_b32 v12, 16, v81
    v_and_b32 v13, 0xffff0000, v81
    v_pk_add_f32 v[62:63], v[62:63], v[12:13]
    v_pk_mul_f32 v[16:17], v[60:61], v[60:61]
    v_mov_b32 v14, v60
    v_mov_b32 v15, v61
    v_pk_fma_f32 v[16:17], v[62:63], v[62:63], v[16:17]
    v_pk_add_f32 v[14:15], v[14:15], v[62:63]
    v_cvt_pk_bf16_f32 v60, v60, v61
    v_cvt_pk_bf16_f32 v61, v62, v63
    ds_write_b64 v5, v[60:61] offset:0
    v_lshlrev_b32 v12, 16, v82
    v_and_b32 v13, 0xffff0000, v82
    v_pk_add_f32 v[64:65], v[64:65], v[12:13]
    v_lshlrev_b32 v12, 16, v83
    v_and_b32 v13, 0xffff0000, v83
    v_pk_add_f32 v[66:67], v[66:67], v[12:13]
    v_pk_fma_f32 v[16:17], v[64:65], v[64:65], v[16:17]
    v_pk_add_f32 v[14:15], v[14:15], v[64:65]
    v_pk_fma_f32 v[16:17], v[66:67], v[66:67], v[16:17]
    v_pk_add_f32 v[14:15], v[14:15], v[66:67]
    v_cvt_pk_bf16_f32 v64, v64, v65
    v_cvt_pk_bf16_f32 v65, v66, v67
    ds_write_b64 v5, v[64:65] offset:512
    v_lshlrev_b32 v12, 16, v84
    v_and_b32 v13, 0xffff0000, v84
    v_pk_add_f32 v[68:69], v[68:69], v[12:13]
    v_lshlrev_b32 v12, 16, v85
    v_and_b32 v13, 0xffff0000, v85
    v_pk_add_f32 v[70:71], v[70:71], v[12:13]
    v_pk_fma_f32 v[16:17], v[68:69], v[68:69], v[16:17]
    v_pk_add_f32 v[14:15], v[14:15], v[68:69]
    v_pk_fma_f32 v[16:17], v[70:71], v[70:71], v[16:17]
    v_pk_add_f32 v[14:15], v[14:15], v[70:71]
    v_cvt_pk_bf16_f32 v68, v68, v69
    v_cvt_pk_bf16_f32 v69, v70, v71
    ds_write_b64 v5, v[68:69] offset:1024
    v_lshlrev_b32 v12, 16, v86
    v_and_b32 v13, 0xffff0000, v86
    v_pk_add_f32 v[72:73], v[72:73], v[12:13]
    v_lshlrev_b32 v12, 16, v87
    v_and_b32 v13, 0xffff0000, v87
    v_pk_add_f32 v[74:75], v[74:75], v[12:13]
    v_pk_fma_f32 v[16:17], v[72:73], v[72:73], v[16:17]
    v_pk_add_f32 v[14:15], v[14:15], v[72:73]
    v_pk_fma_f32 v[16:17], v[74:75], v[74:75], v[16:17]
    v_pk_add_f32 v[14:15], v[14:15], v[74:75]
    v_cvt_pk_bf16_f32 v72, v72, v73
    v_cvt_pk_bf16_f32 v73, v74, v75
    ds_write_b64 v5, v[72:73] offset:1536
    v_lshlrev_b32 v12, 16, v88
    v_and_b32 v13, 0xffff0000, v88
    v_pk_add_f32 v[76:77], v[76:77], v[12:13]
    v_lshlrev_b32 v12, 16, v89
    v_and_b32 v13, 0xffff0000, v89
    v_pk_add_f32 v[78:79], v[78:79], v[12:13]
    v_pk_fma_f32 v[16:17], v[76:77], v[76:77], v[16:17]
    v_pk_add_f32 v[14:15], v[14:15], v[76:77]
    v_pk_fma_f32 v[16:17], v[78:79], v[78:79], v[16:17]
    v_pk_add_f32 v[14:15], v[14:15], v[78:79]
    v_cvt_pk_bf16_f32 v76, v76, v77
    v_cvt_pk_bf16_f32 v77, v78, v79
    ds_write_b64 v5, v[76:77] offset:2048
    s_waitcnt lgkmcnt(0)
    ds_read_b128 v[24:27], v140 offset:0
    ds_read_b128 v[28:31], v140 offset:1024
    ds_read_b128 v[32:35], v140 offset:2048
    v_add_f32 v14, v14, v15
    v_add_f32 v15, v16, v17
    v_mov_b32 v16, v14
    v_mov_b32 v17, v15
    s_nop 0
    v_permlane32_swap_b32 v16, v14
    v_permlane32_swap_b32 v17, v15
    v_add_f32 v14, v14, v16
    v_add_f32 v15, v15, v17
    v_mov_b32 v16, v14
    v_mov_b32 v17, v15
    s_nop 0
    v_permlane16_swap_b32 v16, v14
    v_permlane16_swap_b32 v17, v15
    v_add_f32 v14, v14, v16
    v_add_f32 v15, v15, v17
    s_waitcnt lgkmcnt(0)
    buffer_store_dwordx4 v[24:27], v4, s[12:15], s40 offen sc1
    buffer_store_dwordx4 v[28:31], v4, s[12:15], s40 offen offset:2048 sc1
    s_mov_b32 exec_hi, 0
    buffer_store_dwordx4 v[32:35], v4, s[12:15], s42 offen sc1
    s_mov_b32 exec_lo, 0xffff
    buffer_store_dwordx2 v[14:15], v6, s[12:15], s44 offen sc1
    s_mov_b64 exec, -1
    s_and_b32 s10, s2, 1
    s_lshl_b32 s10, s10, 3
    s_bfe_u32 s11, s2, 0x30003
    s_add_u32 s25, s10, s11
    s_bfe_u32 s10, s2, 0x20001
    s_lshl_b32 s10, s10, 2
    s_lshr_b32 s11, s2, 6
    s_add_u32 s44, s10, s11
    s_mul_i32 s26, s44, 112
    s_min_u32 s26, s26, 1616
    v_lshlrev_b32 v2, 4, v1
    v_lshrrev_b32 v4, 4, v1
    v_and_b32 v3, 15, v1
    s_lshl_b32 s28, s25, 2
    s_add_u32 s28, s28, s24
    s_lshl_b32 s33, s24, 12
    v_lshlrev_b32 v6, 9, v4
    v_lshl_add_u32 v6, v3, 4, v6
    v_add_u32 v6, s33, v6
    v_lshrrev_b32 v7, 1, v4
    v_lshlrev_b32 v7, 4, v7
    v_and_b32 v8, 1, v4
    v_lshl_add_u32 v7, v8, 2, v7
    v_bfe_u32 v8, v1, 2, 2
    v_add_u32 v7, v7, v8
    v_mul_u32_u24 v7, 224, v7
    v_and_b32 v8, 3, v1
    v_lshl_add_u32 v7, v8, 3, v7
    v_add_u32 v7, 16384, v7
    v_mov_b32 v8, v6
    v_mov_b32 v9, v7
    s_mov_b32 s37, 0
    s_mov_b32 s38, 0
    v_lshlrev_b32 v5, 4, v4
    v_add_u32 v5, 135936, v5
    s_lshl_b32 s33, s24, 9
    s_add_u32 s33, s33, 136960
    v_lshl_add_u32 v3, v3, 4, s33
    s_mul_i32 s40, s28, 110592
    s_lshl_b32 s33, s26, 6
    s_add_u32 s40, s40, s33
    s_add_u32 s40, s40, 15859712
    s_add_u32 s41, s40, 4096
    s_lshl_b32 s53, s25, 8
    s_lshl_b32 s33, s44, 2
    s_add_u32 s33, s33, s24
    s_lshl_b32 s33, s33, 2
    s_add_u32 s53, s53, s33
    s_add_u32 s53, s53, 30781440
    v_mov_b32 v10, 1
    v_mov_b32 v11, 0
    s_waitcnt vmcnt(0)
    s_mov_b64 exec, 1
    buffer_store_dword v10, v11, s[12:15], s50 offen sc1
    s_mov_b64 exec, -1
    s_barrier
    v_mov_b32 v56, 0
    v_mov_b32 v57, 0
    v_mov_b32 v58, 0
    v_mov_b32 v59, 0
    v_mov_b32 v60, 0
    v_mov_b32 v61, 0
    v_mov_b32 v62, 0
    v_mov_b32 v63, 0
    v_mov_b32 v64, 0
    v_mov_b32 v65, 0
    v_mov_b32 v66, 0
    v_mov_b32 v67, 0
    v_mov_b32 v68, 0
    v_mov_b32 v69, 0
    v_mov_b32 v70, 0
    v_mov_b32 v71, 0
    v_mov_b32 v72, 0
    v_mov_b32 v73, 0
    v_mov_b32 v74, 0
    v_mov_b32 v75, 0
    v_mov_b32 v76, 0
    v_mov_b32 v77, 0
    v_mov_b32 v78, 0
    v_mov_b32 v79, 0
    v_mov_b32 v80, 0
    v_mov_b32 v81, 0
    v_mov_b32 v82, 0
    v_mov_b32 v83, 0
    v_mov_b32 v84, 0
    v_mov_b32 v85, 0
    v_mov_b32 v86, 0
    v_mov_b32 v87, 0
    v_mov_b32 v88, 0
    v_mov_b32 v89, 0
    v_mov_b32 v90, 0
    v_mov_b32 v91, 0
    v_mov_b32 v92, 0
    v_mov_b32 v93, 0
    v_mov_b32 v94, 0
    v_mov_b32 v95, 0
    v_mov_b32 v96, 0
    v_mov_b32 v97, 0
    v_mov_b32 v98, 0
    v_mov_b32 v99, 0
    v_mov_b32 v100, 0
    v_mov_b32 v101, 0
    v_mov_b32 v102, 0
    v_mov_b32 v103, 0
    v_mov_b32 v104, 0
    v_mov_b32 v105, 0
    v_mov_b32 v106, 0
    v_mov_b32 v107, 0
    v_mov_b32 v108, 0
    v_mov_b32 v109, 0
    v_mov_b32 v110, 0
    v_mov_b32 v111, 0
    v_mov_b32 v112, 0
    v_mov_b32 v113, 0
    v_mov_b32 v114, 0
    v_mov_b32 v115, 0
    v_mov_b32 v116, 0
    v_mov_b32 v117, 0
    v_mov_b32 v118, 0
    v_mov_b32 v119, 0
    v_mov_b32 v120, 0
    v_mov_b32 v121, 0
    v_mov_b32 v122, 0
    v_mov_b32 v123, 0
    v_mov_b32 v124, 0
    v_mov_b32 v125, 0
    v_mov_b32 v126, 0
    v_mov_b32 v127, 0
    v_mov_b32 v128, 0
    v_mov_b32 v129, 0
    v_mov_b32 v130, 0
    v_mov_b32 v131, 0
    v_mov_b32 v132, 0
    v_mov_b32 v133, 0
    v_mov_b32 v134, 0
    v_mov_b32 v135, 0
    v_mov_b32 v136, 0
    v_mov_b32 v137, 0
    v_mov_b32 v138, 0
    v_mov_b32 v139, 0
    v_mov_b32 v140, 0
    v_mov_b32 v141, 0
    v_mov_b32 v142, 0
    v_mov_b32 v143, 0
    v_mov_b32 v144, 0
    v_mov_b32 v145, 0
    v_mov_b32 v146, 0
    v_mov_b32 v147, 0
    v_mov_b32 v148, 0
    v_mov_b32 v149, 0
    v_mov_b32 v150, 0
    v_mov_b32 v151, 0
    v_mov_b32 v152, 0
    v_mov_b32 v153, 0
    v_mov_b32 v154, 0
    v_mov_b32 v155, 0
    v_mov_b32 v156, 0
    v_mov_b32 v157, 0
    v_mov_b32 v158, 0
    v_mov_b32 v159, 0
    v_mov_b32 v160, 0
    v_mov_b32 v161, 0
    v_mov_b32 v162, 0
    v_mov_b32 v163, 0
    v_mov_b32 v164, 0
    v_mov_b32 v165, 0
    v_mov_b32 v166, 0
    v_mov_b32 v167, 0
    s_barrier
    s_barrier
    ds_read_b128 v[12:15], v8 offset:0
    ds_read_b128 v[16:19], v8 offset:256
    ds_read_b64_tr_b16 v[28:29], v9 offset:0
    ds_read_b64_tr_b16 v[30:31], v9 offset:1792
    ds_read_b64_tr_b16 v[32:33], v9 offset:14464
    ds_read_b64_tr_b16 v[34:35], v9 offset:16256
    ds_read_b64_tr_b16 v[36:37], v9 offset:32
    ds_read_b64_tr_b16 v[38:39], v9 offset:1824
    ds_read_b64_tr_b16 v[40:41], v9 offset:14496
    ds_read_b64_tr_b16 v[42:43], v9 offset:16288
    ds_read_b64_tr_b16 v[44:45], v9 offset:64
    ds_read_b64_tr_b16 v[46:47], v9 offset:1856
    ds_read_b64_tr_b16 v[48:49], v9 offset:14528
    ds_read_b64_tr_b16 v[50:51], v9 offset:16320
    ds_read_b64_tr_b16 v[52:53], v9 offset:96
    ds_read_b64_tr_b16 v[54:55], v9 offset:1888
.p2align 6
L_p4_loop:
    s_waitcnt lgkmcnt(10)
    v_mfma_f32_16x16x32_bf16 v[56:59], v[28:31], v[12:15], v[56:59]
    ds_read_b64_tr_b16 v[52:53], v9 offset:96
    v_mfma_f32_16x16x32_bf16 v[60:63], v[28:31], v[16:19], v[60:63]
    ds_read_b64_tr_b16 v[54:55], v9 offset:1888
    s_waitcnt lgkmcnt(10)
    v_mfma_f32_16x16x32_bf16 v[64:67], v[32:35], v[12:15], v[64:67]
    ds_read_b64_tr_b16 v[28:29], v9 offset:14560
    v_mfma_f32_16x16x32_bf16 v[68:71], v[32:35], v[16:19], v[68:71]
    ds_read_b64_tr_b16 v[30:31], v9 offset:16352
    s_waitcnt lgkmcnt(10)
    v_mfma_f32_16x16x32_bf16 v[72:75], v[36:39], v[12:15], v[72:75]
    ds_read_b128 v[20:23], v8 offset:2048
    ds_read_b128 v[24:27], v8 offset:2304
    v_mfma_f32_16x16x32_bf16 v[76:79], v[36:39], v[16:19], v[76:79]
    ds_read_b64_tr_b16 v[32:33], v9 offset:128
    ds_read_b64_tr_b16 v[34:35], v9 offset:1920
    s_waitcnt lgkmcnt(10)
    v_mfma_f32_16x16x32_bf16 v[80:83], v[40:43], v[12:15], v[80:83]
    ds_read_b64_tr_b16 v[36:37], v9 offset:14592
    v_mfma_f32_16x16x32_bf16 v[84:87], v[40:43], v[16:19], v[84:87]
    ds_read_b64_tr_b16 v[38:39], v9 offset:16384
    s_waitcnt lgkmcnt(10)
    v_mfma_f32_16x16x32_bf16 v[88:91], v[44:47], v[12:15], v[88:91]
    ds_read_b64_tr_b16 v[40:41], v9 offset:160
    v_mfma_f32_16x16x32_bf16 v[92:95], v[44:47], v[16:19], v[92:95]
    ds_read_b64_tr_b16 v[42:43], v9 offset:1952
    s_waitcnt lgkmcnt(10)
    v_mfma_f32_16x16x32_bf16 v[96:99], v[48:51], v[12:15], v[96:99]
    ds_read_b64_tr_b16 v[44:45], v9 offset:14624
    v_mfma_f32_16x16x32_bf16 v[100:103], v[48:51], v[16:19], v[100:103]
    ds_read_b64_tr_b16 v[46:47], v9 offset:16416
    s_waitcnt lgkmcnt(10)
    v_mfma_f32_16x16x32_bf16 v[104:107], v[52:55], v[12:15], v[104:107]
    ds_read_b64_tr_b16 v[48:49], v9 offset:192
    v_mfma_f32_16x16x32_bf16 v[108:111], v[52:55], v[16:19], v[108:111]
    ds_read_b64_tr_b16 v[50:51], v9 offset:1984
    s_waitcnt lgkmcnt(10)
    v_mfma_f32_16x16x32_bf16 v[112:115], v[28:31], v[12:15], v[112:115]
    ds_read_b64_tr_b16 v[52:53], v9 offset:14656
    v_mfma_f32_16x16x32_bf16 v[116:119], v[28:31], v[16:19], v[116:119]
    ds_read_b64_tr_b16 v[54:55], v9 offset:16448
    s_waitcnt lgkmcnt(10)
    v_mfma_f32_16x16x32_bf16 v[120:123], v[32:35], v[12:15], v[120:123]
    ds_read_b64_tr_b16 v[28:29], v9 offset:7168
    v_mfma_f32_16x16x32_bf16 v[124:127], v[32:35], v[16:19], v[124:127]
    ds_read_b64_tr_b16 v[30:31], v9 offset:8960
    s_waitcnt lgkmcnt(10)
    v_mfma_f32_16x16x32_bf16 v[128:131], v[36:39], v[12:15], v[128:131]
    ds_read_b64_tr_b16 v[32:33], v9 offset:21632
    v_mfma_f32_16x16x32_bf16 v[132:135], v[36:39], v[16:19], v[132:135]
    ds_read_b64_tr_b16 v[34:35], v9 offset:23424
    s_waitcnt lgkmcnt(10)
    v_mfma_f32_16x16x32_bf16 v[136:139], v[40:43], v[12:15], v[136:139]
    ds_read_b64_tr_b16 v[36:37], v9 offset:7200
    v_mfma_f32_16x16x32_bf16 v[140:143], v[40:43], v[16:19], v[140:143]
    ds_read_b64_tr_b16 v[38:39], v9 offset:8992
    s_waitcnt lgkmcnt(10)
    v_mfma_f32_16x16x32_bf16 v[144:147], v[44:47], v[12:15], v[144:147]
    ds_read_b64_tr_b16 v[40:41], v9 offset:21664
    v_mfma_f32_16x16x32_bf16 v[148:151], v[44:47], v[16:19], v[148:151]
    ds_read_b64_tr_b16 v[42:43], v9 offset:23456
    s_waitcnt lgkmcnt(10)
    v_mfma_f32_16x16x32_bf16 v[152:155], v[48:51], v[12:15], v[152:155]
    ds_read_b64_tr_b16 v[44:45], v9 offset:7232
    v_mfma_f32_16x16x32_bf16 v[156:159], v[48:51], v[16:19], v[156:159]
    ds_read_b64_tr_b16 v[46:47], v9 offset:9024
    s_waitcnt lgkmcnt(10)
    v_mfma_f32_16x16x32_bf16 v[160:163], v[52:55], v[12:15], v[160:163]
    ds_read_b64_tr_b16 v[48:49], v9 offset:21696
    v_mfma_f32_16x16x32_bf16 v[164:167], v[52:55], v[16:19], v[164:167]
    ds_read_b64_tr_b16 v[50:51], v9 offset:23488
    s_waitcnt lgkmcnt(10)
    v_mfma_f32_16x16x32_bf16 v[56:59], v[28:31], v[20:23], v[56:59]
    ds_read_b64_tr_b16 v[52:53], v9 offset:7264
    v_mfma_f32_16x16x32_bf16 v[60:63], v[28:31], v[24:27], v[60:63]
    ds_read_b64_tr_b16 v[54:55], v9 offset:9056
    s_waitcnt lgkmcnt(10)
    v_mfma_f32_16x16x32_bf16 v[64:67], v[32:35], v[20:23], v[64:67]
    ds_read_b64_tr_b16 v[28:29], v9 offset:21728
    v_mfma_f32_16x16x32_bf16 v[68:71], v[32:35], v[24:27], v[68:71]
    ds_read_b64_tr_b16 v[30:31], v9 offset:23520
    s_waitcnt lgkmcnt(10)
    v_mfma_f32_16x16x32_bf16 v[72:75], v[36:39], v[20:23], v[72:75]
    ds_read_b64_tr_b16 v[32:33], v9 offset:7296
    v_mfma_f32_16x16x32_bf16 v[76:79], v[36:39], v[24:27], v[76:79]
    ds_read_b64_tr_b16 v[34:35], v9 offset:9088
    s_waitcnt lgkmcnt(10)
    v_mfma_f32_16x16x32_bf16 v[80:83], v[40:43], v[20:23], v[80:83]
    ds_read_b64_tr_b16 v[36:37], v9 offset:21760
    v_mfma_f32_16x16x32_bf16 v[84:87], v[40:43], v[24:27], v[84:87]
    ds_read_b64_tr_b16 v[38:39], v9 offset:23552
    s_waitcnt lgkmcnt(10)
    v_mfma_f32_16x16x32_bf16 v[88:91], v[44:47], v[20:23], v[88:91]
    ds_read_b64_tr_b16 v[40:41], v9 offset:7328
    v_mfma_f32_16x16x32_bf16 v[92:95], v[44:47], v[24:27], v[92:95]
    ds_read_b64_tr_b16 v[42:43], v9 offset:9120
    s_waitcnt lgkmcnt(10)
    v_mfma_f32_16x16x32_bf16 v[96:99], v[48:51], v[20:23], v[96:99]
    ds_read_b64_tr_b16 v[44:45], v9 offset:21792
    v_mfma_f32_16x16x32_bf16 v[100:103], v[48:51], v[24:27], v[100:103]
    ds_read_b64_tr_b16 v[46:47], v9 offset:23584
    s_waitcnt lgkmcnt(10)
    v_mfma_f32_16x16x32_bf16 v[104:107], v[52:55], v[20:23], v[104:107]
    ds_read_b64_tr_b16 v[48:49], v9 offset:7360
    v_mfma_f32_16x16x32_bf16 v[108:111], v[52:55], v[24:27], v[108:111]
    ds_read_b64_tr_b16 v[50:51], v9 offset:9152
    s_waitcnt lgkmcnt(10)
    v_mfma_f32_16x16x32_bf16 v[112:115], v[28:31], v[20:23], v[112:115]
    ds_read_b64_tr_b16 v[52:53], v9 offset:21824
    v_mfma_f32_16x16x32_bf16 v[116:119], v[28:31], v[24:27], v[116:119]
    ds_read_b64_tr_b16 v[54:55], v9 offset:23616
    s_add_u32 s37, s37, 45312
    s_cmp_lt_u32 s37, 135936
    s_cselect_b32 s37, s37, 0
    v_add_u32 v8, s37, v6
    v_add_u32 v9, s37, v7
    s_waitcnt lgkmcnt(10)
    v_mfma_f32_16x16x32_bf16 v[120:123], v[32:35], v[20:23], v[120:123]
    v_mfma_f32_16x16x32_bf16 v[124:127], v[32:35], v[24:27], v[124:127]
    s_waitcnt lgkmcnt(8)
    v_mfma_f32_16x16x32_bf16 v[128:131], v[36:39], v[20:23], v[128:131]
    v_mfma_f32_16x16x32_bf16 v[132:135], v[36:39], v[24:27], v[132:135]
    s_waitcnt lgkmcnt(0)
    v_mfma_f32_16x16x32_bf16 v[136:139], v[40:43], v[20:23], v[136:139]
    s_barrier
    ds_read_b128 v[12:15], v8 offset:0
    ds_read_b128 v[16:19], v8 offset:256
    v_mfma_f32_16x16x32_bf16 v[140:143], v[40:43], v[24:27], v[140:143]
    ds_read_b64_tr_b16 v[28:29], v9 offset:0
    ds_read_b64_tr_b16 v[30:31], v9 offset:1792
    v_mfma_f32_16x16x32_bf16 v[144:147], v[44:47], v[20:23], v[144:147]
    ds_read_b64_tr_b16 v[32:33], v9 offset:14464
    ds_read_b64_tr_b16 v[34:35], v9 offset:16256
    v_mfma_f32_16x16x32_bf16 v[148:151], v[44:47], v[24:27], v[148:151]
    ds_read_b64_tr_b16 v[36:37], v9 offset:32
    ds_read_b64_tr_b16 v[38:39], v9 offset:1824
    v_mfma_f32_16x16x32_bf16 v[152:155], v[48:51], v[20:23], v[152:155]
    ds_read_b64_tr_b16 v[40:41], v9 offset:14496
    ds_read_b64_tr_b16 v[42:43], v9 offset:16288
    v_mfma_f32_16x16x32_bf16 v[156:159], v[48:51], v[24:27], v[156:159]
    ds_read_b64_tr_b16 v[44:45], v9 offset:64
    ds_read_b64_tr_b16 v[46:47], v9 offset:1856
    v_mfma_f32_16x16x32_bf16 v[160:163], v[52:55], v[20:23], v[160:163]
    ds_read_b64_tr_b16 v[48:49], v9 offset:14528
    v_mfma_f32_16x16x32_bf16 v[164:167], v[52:55], v[24:27], v[164:167]
    ds_read_b64_tr_b16 v[50:51], v9 offset:16320
    s_add_u32 s38, s38, 1
    s_cmp_lt_u32 s38, 10
    s_cbranch_scc1 L_p4_loop
    s_waitcnt lgkmcnt(0)
    ds_read_b128 v[36:39], v3
    ds_read_b128 v[40:43], v3 offset:256
    ds_read_b128 v[12:15], v5 offset:0
    ds_read_b128 v[16:19], v5 offset:448
    ds_read_b128 v[20:23], v5 offset:64
    ds_read_b128 v[24:27], v5 offset:512
    s_waitcnt lgkmcnt(2)
    v_pk_fma_f32 v[56:57], v[12:13], v[36:37], v[56:57] op_sel:[0,0,0] op_sel_hi:[1,0,1]
    v_pk_fma_f32 v[58:59], v[14:15], v[36:37], v[58:59] op_sel:[0,0,0] op_sel_hi:[1,0,1]
    v_pk_fma_f32 v[60:61], v[12:13], v[40:41], v[60:61] op_sel:[0,0,0] op_sel_hi:[1,0,1]
    v_pk_fma_f32 v[62:63], v[14:15], v[40:41], v[62:63] op_sel:[0,0,0] op_sel_hi:[1,0,1]
    v_pk_fma_f32 v[64:65], v[16:17], v[36:37], v[64:65] op_sel:[0,0,0] op_sel_hi:[1,0,1]
    v_pk_fma_f32 v[66:67], v[18:19], v[36:37], v[66:67] op_sel:[0,0,0] op_sel_hi:[1,0,1]
    v_pk_fma_f32 v[68:69], v[16:17], v[40:41], v[68:69] op_sel:[0,0,0] op_sel_hi:[1,0,1]
    v_pk_fma_f32 v[70:71], v[18:19], v[40:41], v[70:71] op_sel:[0,0,0] op_sel_hi:[1,0,1]
    v_pk_mul_f32 v[44:45], v[56:57], v[56:57]
    v_pk_mul_f32 v[46:47], v[58:59], v[58:59]
    v_pk_mul_f32 v[48:49], v[60:61], v[60:61]
    v_pk_mul_f32 v[50:51], v[62:63], v[62:63]
    v_pk_fma_f32 v[44:45], v[44:45], v[38:39], v[36:37] op_sel:[0,0,1] op_sel_hi:[1,0,1]
    v_pk_fma_f32 v[46:47], v[46:47], v[38:39], v[36:37] op_sel:[0,0,1] op_sel_hi:[1,0,1]
    v_pk_fma_f32 v[48:49], v[48:49], v[42:43], v[40:41] op_sel:[0,0,1] op_sel_hi:[1,0,1]
    v_pk_fma_f32 v[50:51], v[50:51], v[42:43], v[40:41] op_sel:[0,0,1] op_sel_hi:[1,0,1]
    v_pk_mul_f32 v[44:45], v[44:45], v[56:57]
    v_pk_mul_f32 v[46:47], v[46:47], v[58:59]
    v_pk_mul_f32 v[48:49], v[48:49], v[60:61]
    v_pk_mul_f32 v[50:51], v[50:51], v[62:63]
    v_exp_f32 v44, v44
    v_exp_f32 v45, v45
    v_exp_f32 v46, v46
    v_exp_f32 v47, v47
    v_exp_f32 v48, v48
    v_exp_f32 v49, v49
    v_exp_f32 v50, v50
    v_exp_f32 v51, v51
    v_pk_mul_f32 v[56:57], v[56:57], v[64:65]
    v_pk_mul_f32 v[58:59], v[58:59], v[66:67]
    v_pk_mul_f32 v[60:61], v[60:61], v[68:69]
    v_pk_mul_f32 v[62:63], v[62:63], v[70:71]
    v_pk_fma_f32 v[44:45], v[44:45], v[38:39], v[38:39] op_sel:[0,1,1] op_sel_hi:[1,1,1]
    v_pk_fma_f32 v[46:47], v[46:47], v[38:39], v[38:39] op_sel:[0,1,1] op_sel_hi:[1,1,1]
    v_pk_fma_f32 v[48:49], v[48:49], v[42:43], v[42:43] op_sel:[0,1,1] op_sel_hi:[1,1,1]
    v_pk_fma_f32 v[50:51], v[50:51], v[42:43], v[42:43] op_sel:[0,1,1] op_sel_hi:[1,1,1]
    v_rcp_f32 v44, v44
    v_rcp_f32 v45, v45
    v_rcp_f32 v46, v46
    v_rcp_f32 v47, v47
    v_rcp_f32 v48, v48
    v_rcp_f32 v49, v49
    v_rcp_f32 v50, v50
    v_rcp_f32 v51, v51
    v_pk_mul_f32 v[56:57], v[56:57], v[44:45]
    v_pk_mul_f32 v[58:59], v[58:59], v[46:47]
    v_pk_mul_f32 v[60:61], v[60:61], v[48:49]
    v_pk_mul_f32 v[62:63], v[62:63], v[50:51]
    v_cvt_pk_bf16_f32 v64, v56, v57
    v_cvt_pk_bf16_f32 v65, v58, v59
    v_cvt_pk_bf16_f32 v66, v60, v61
    v_cvt_pk_bf16_f32 v67, v62, v63
    s_nop 0
    v_permlane16_swap_b32 v64, v66
    v_permlane16_swap_b32 v65, v67
    buffer_store_dwordx4 v[64:67], v2, s[12:15], s40 offen offset:0 sc1
    ds_read_b128 v[12:15], v5 offset:128
    ds_read_b128 v[16:19], v5 offset:576
    s_waitcnt lgkmcnt(2)
    v_pk_fma_f32 v[72:73], v[20:21], v[36:37], v[72:73] op_sel:[0,0,0] op_sel_hi:[1,0,1]
    v_pk_fma_f32 v[74:75], v[22:23], v[36:37], v[74:75] op_sel:[0,0,0] op_sel_hi:[1,0,1]
    v_pk_fma_f32 v[76:77], v[20:21], v[40:41], v[76:77] op_sel:[0,0,0] op_sel_hi:[1,0,1]
    v_pk_fma_f32 v[78:79], v[22:23], v[40:41], v[78:79] op_sel:[0,0,0] op_sel_hi:[1,0,1]
    v_pk_fma_f32 v[80:81], v[24:25], v[36:37], v[80:81] op_sel:[0,0,0] op_sel_hi:[1,0,1]
    v_pk_fma_f32 v[82:83], v[26:27], v[36:37], v[82:83] op_sel:[0,0,0] op_sel_hi:[1,0,1]
    v_pk_fma_f32 v[84:85], v[24:25], v[40:41], v[84:85] op_sel:[0,0,0] op_sel_hi:[1,0,1]
    v_pk_fma_f32 v[86:87], v[26:27], v[40:41], v[86:87] op_sel:[0,0,0] op_sel_hi:[1,0,1]
    v_pk_mul_f32 v[44:45], v[72:73], v[72:73]
    v_pk_mul_f32 v[46:47], v[74:75], v[74:75]
    v_pk_mul_f32 v[48:49], v[76:77], v[76:77]
    v_pk_mul_f32 v[50:51], v[78:79], v[78:79]
    v_pk_fma_f32 v[44:45], v[44:45], v[38:39], v[36:37] op_sel:[0,0,1] op_sel_hi:[1,0,1]
    v_pk_fma_f32 v[46:47], v[46:47], v[38:39], v[36:37] op_sel:[0,0,1] op_sel_hi:[1,0,1]
    v_pk_fma_f32 v[48:49], v[48:49], v[42:43], v[40:41] op_sel:[0,0,1] op_sel_hi:[1,0,1]
    v_pk_fma_f32 v[50:51], v[50:51], v[42:43], v[40:41] op_sel:[0,0,1] op_sel_hi:[1,0,1]
    v_pk_mul_f32 v[44:45], v[44:45], v[72:73]
    v_pk_mul_f32 v[46:47], v[46:47], v[74:75]
    v_pk_mul_f32 v[48:49], v[48:49], v[76:77]
    v_pk_mul_f32 v[50:51], v[50:51], v[78:79]
    v_exp_f32 v44, v44
    v_exp_f32 v45, v45
    v_exp_f32 v46, v46
    v_exp_f32 v47, v47
    v_exp_f32 v48, v48
    v_exp_f32 v49, v49
    v_exp_f32 v50, v50
    v_exp_f32 v51, v51
    v_pk_mul_f32 v[72:73], v[72:73], v[80:81]
    v_pk_mul_f32 v[74:75], v[74:75], v[82:83]
    v_pk_mul_f32 v[76:77], v[76:77], v[84:85]
    v_pk_mul_f32 v[78:79], v[78:79], v[86:87]
    v_pk_fma_f32 v[44:45], v[44:45], v[38:39], v[38:39] op_sel:[0,1,1] op_sel_hi:[1,1,1]
    v_pk_fma_f32 v[46:47], v[46:47], v[38:39], v[38:39] op_sel:[0,1,1] op_sel_hi:[1,1,1]
    v_pk_fma_f32 v[48:49], v[48:49], v[42:43], v[42:43] op_sel:[0,1,1] op_sel_hi:[1,1,1]
    v_pk_fma_f32 v[50:51], v[50:51], v[42:43], v[42:43] op_sel:[0,1,1] op_sel_hi:[1,1,1]
    v_rcp_f32 v44, v44
    v_rcp_f32 v45, v45
    v_rcp_f32 v46, v46
    v_rcp_f32 v47, v47
    v_rcp_f32 v48, v48
    v_rcp_f32 v49, v49
    v_rcp_f32 v50, v50
    v_rcp_f32 v51, v51
    v_pk_mul_f32 v[72:73], v[72:73], v[44:45]
    v_pk_mul_f32 v[74:75], v[74:75], v[46:47]
    v_pk_mul_f32 v[76:77], v[76:77], v[48:49]
    v_pk_mul_f32 v[78:79], v[78:79], v[50:51]
    v_cvt_pk_bf16_f32 v80, v72, v73
    v_cvt_pk_bf16_f32 v81, v74, v75
    v_cvt_pk_bf16_f32 v82, v76, v77
    v_cvt_pk_bf16_f32 v83, v78, v79
    s_nop 0
    v_permlane16_swap_b32 v80, v82
    v_permlane16_swap_b32 v81, v83
    buffer_store_dwordx4 v[80:83], v2, s[12:15], s40 offen offset:1024 sc1
    ds_read_b128 v[20:23], v5 offset:192
    ds_read_b128 v[24:27], v5 offset:640
    s_waitcnt lgkmcnt(2)
    v_pk_fma_f32 v[88:89], v[12:13], v[36:37], v[88:89] op_sel:[0,0,0] op_sel_hi:[1,0,1]
    v_pk_fma_f32 v[90:91], v[14:15], v[36:37], v[90:91] op_sel:[0,0,0] op_sel_hi:[1,0,1]
    v_pk_fma_f32 v[92:93], v[12:13], v[40:41], v[92:93] op_sel:[0,0,0] op_sel_hi:[1,0,1]
    v_pk_fma_f32 v[94:95], v[14:15], v[40:41], v[94:95] op_sel:[0,0,0] op_sel_hi:[1,0,1]
    v_pk_fma_f32 v[96:97], v[16:17], v[36:37], v[96:97] op_sel:[0,0,0] op_sel_hi:[1,0,1]
    v_pk_fma_f32 v[98:99], v[18:19], v[36:37], v[98:99] op_sel:[0,0,0] op_sel_hi:[1,0,1]
    v_pk_fma_f32 v[100:101], v[16:17], v[40:41], v[100:101] op_sel:[0,0,0] op_sel_hi:[1,0,1]
    v_pk_fma_f32 v[102:103], v[18:19], v[40:41], v[102:103] op_sel:[0,0,0] op_sel_hi:[1,0,1]
    v_pk_mul_f32 v[44:45], v[88:89], v[88:89]
    v_pk_mul_f32 v[46:47], v[90:91], v[90:91]
    v_pk_mul_f32 v[48:49], v[92:93], v[92:93]
    v_pk_mul_f32 v[50:51], v[94:95], v[94:95]
    v_pk_fma_f32 v[44:45], v[44:45], v[38:39], v[36:37] op_sel:[0,0,1] op_sel_hi:[1,0,1]
    v_pk_fma_f32 v[46:47], v[46:47], v[38:39], v[36:37] op_sel:[0,0,1] op_sel_hi:[1,0,1]
    v_pk_fma_f32 v[48:49], v[48:49], v[42:43], v[40:41] op_sel:[0,0,1] op_sel_hi:[1,0,1]
    v_pk_fma_f32 v[50:51], v[50:51], v[42:43], v[40:41] op_sel:[0,0,1] op_sel_hi:[1,0,1]
    v_pk_mul_f32 v[44:45], v[44:45], v[88:89]
    v_pk_mul_f32 v[46:47], v[46:47], v[90:91]
    v_pk_mul_f32 v[48:49], v[48:49], v[92:93]
    v_pk_mul_f32 v[50:51], v[50:51], v[94:95]
    v_exp_f32 v44, v44
    v_exp_f32 v45, v45
    v_exp_f32 v46, v46
    v_exp_f32 v47, v47
    v_exp_f32 v48, v48
    v_exp_f32 v49, v49
    v_exp_f32 v50, v50
    v_exp_f32 v51, v51
    v_pk_mul_f32 v[88:89], v[88:89], v[96:97]
    v_pk_mul_f32 v[90:91], v[90:91], v[98:99]
    v_pk_mul_f32 v[92:93], v[92:93], v[100:101]
    v_pk_mul_f32 v[94:95], v[94:95], v[102:103]
    v_pk_fma_f32 v[44:45], v[44:45], v[38:39], v[38:39] op_sel:[0,1,1] op_sel_hi:[1,1,1]
    v_pk_fma_f32 v[46:47], v[46:47], v[38:39], v[38:39] op_sel:[0,1,1] op_sel_hi:[1,1,1]
    v_pk_fma_f32 v[48:49], v[48:49], v[42:43], v[42:43] op_sel:[0,1,1] op_sel_hi:[1,1,1]
    v_pk_fma_f32 v[50:51], v[50:51], v[42:43], v[42:43] op_sel:[0,1,1] op_sel_hi:[1,1,1]
    v_rcp_f32 v44, v44
    v_rcp_f32 v45, v45
    v_rcp_f32 v46, v46
    v_rcp_f32 v47, v47
    v_rcp_f32 v48, v48
    v_rcp_f32 v49, v49
    v_rcp_f32 v50, v50
    v_rcp_f32 v51, v51
    v_pk_mul_f32 v[88:89], v[88:89], v[44:45]
    v_pk_mul_f32 v[90:91], v[90:91], v[46:47]
    v_pk_mul_f32 v[92:93], v[92:93], v[48:49]
    v_pk_mul_f32 v[94:95], v[94:95], v[50:51]
    v_cvt_pk_bf16_f32 v96, v88, v89
    v_cvt_pk_bf16_f32 v97, v90, v91
    v_cvt_pk_bf16_f32 v98, v92, v93
    v_cvt_pk_bf16_f32 v99, v94, v95
    s_nop 0
    v_permlane16_swap_b32 v96, v98
    v_permlane16_swap_b32 v97, v99
    buffer_store_dwordx4 v[96:99], v2, s[12:15], s40 offen offset:2048 sc1
    ds_read_b128 v[12:15], v5 offset:256
    ds_read_b128 v[16:19], v5 offset:704
    s_waitcnt lgkmcnt(2)
    v_pk_fma_f32 v[104:105], v[20:21], v[36:37], v[104:105] op_sel:[0,0,0] op_sel_hi:[1,0,1]
    v_pk_fma_f32 v[106:107], v[22:23], v[36:37], v[106:107] op_sel:[0,0,0] op_sel_hi:[1,0,1]
    v_pk_fma_f32 v[108:109], v[20:21], v[40:41], v[108:109] op_sel:[0,0,0] op_sel_hi:[1,0,1]
    v_pk_fma_f32 v[110:111], v[22:23], v[40:41], v[110:111] op_sel:[0,0,0] op_sel_hi:[1,0,1]
    v_pk_fma_f32 v[112:113], v[24:25], v[36:37], v[112:113] op_sel:[0,0,0] op_sel_hi:[1,0,1]
    v_pk_fma_f32 v[114:115], v[26:27], v[36:37], v[114:115] op_sel:[0,0,0] op_sel_hi:[1,0,1]
    v_pk_fma_f32 v[116:117], v[24:25], v[40:41], v[116:117] op_sel:[0,0,0] op_sel_hi:[1,0,1]
    v_pk_fma_f32 v[118:119], v[26:27], v[40:41], v[118:119] op_sel:[0,0,0] op_sel_hi:[1,0,1]
    v_pk_mul_f32 v[44:45], v[104:105], v[104:105]
    v_pk_mul_f32 v[46:47], v[106:107], v[106:107]
    v_pk_mul_f32 v[48:49], v[108:109], v[108:109]
    v_pk_mul_f32 v[50:51], v[110:111], v[110:111]
    v_pk_fma_f32 v[44:45], v[44:45], v[38:39], v[36:37] op_sel:[0,0,1] op_sel_hi:[1,0,1]
    v_pk_fma_f32 v[46:47], v[46:47], v[38:39], v[36:37] op_sel:[0,0,1] op_sel_hi:[1,0,1]
    v_pk_fma_f32 v[48:49], v[48:49], v[42:43], v[40:41] op_sel:[0,0,1] op_sel_hi:[1,0,1]
    v_pk_fma_f32 v[50:51], v[50:51], v[42:43], v[40:41] op_sel:[0,0,1] op_sel_hi:[1,0,1]
    v_pk_mul_f32 v[44:45], v[44:45], v[104:105]
    v_pk_mul_f32 v[46:47], v[46:47], v[106:107]
    v_pk_mul_f32 v[48:49], v[48:49], v[108:109]
    v_pk_mul_f32 v[50:51], v[50:51], v[110:111]
    v_exp_f32 v44, v44
    v_exp_f32 v45, v45
    v_exp_f32 v46, v46
    v_exp_f32 v47, v47
    v_exp_f32 v48, v48
    v_exp_f32 v49, v49
    v_exp_f32 v50, v50
    v_exp_f32 v51, v51
    v_pk_mul_f32 v[104:105], v[104:105], v[112:113]
    v_pk_mul_f32 v[106:107], v[106:107], v[114:115]
    v_pk_mul_f32 v[108:109], v[108:109], v[116:117]
    v_pk_mul_f32 v[110:111], v[110:111], v[118:119]
    v_pk_fma_f32 v[44:45], v[44:45], v[38:39], v[38:39] op_sel:[0,1,1] op_sel_hi:[1,1,1]
    v_pk_fma_f32 v[46:47], v[46:47], v[38:39], v[38:39] op_sel:[0,1,1] op_sel_hi:[1,1,1]
    v_pk_fma_f32 v[48:49], v[48:49], v[42:43], v[42:43] op_sel:[0,1,1] op_sel_hi:[1,1,1]
    v_pk_fma_f32 v[50:51], v[50:51], v[42:43], v[42:43] op_sel:[0,1,1] op_sel_hi:[1,1,1]
    v_rcp_f32 v44, v44
    v_rcp_f32 v45, v45
    v_rcp_f32 v46, v46
    v_rcp_f32 v47, v47
    v_rcp_f32 v48, v48
    v_rcp_f32 v49, v49
    v_rcp_f32 v50, v50
    v_rcp_f32 v51, v51
    v_pk_mul_f32 v[104:105], v[104:105], v[44:45]
    v_pk_mul_f32 v[106:107], v[106:107], v[46:47]
    v_pk_mul_f32 v[108:109], v[108:109], v[48:49]
    v_pk_mul_f32 v[110:111], v[110:111], v[50:51]
    v_cvt_pk_bf16_f32 v112, v104, v105
    v_cvt_pk_bf16_f32 v113, v106, v107
    v_cvt_pk_bf16_f32 v114, v108, v109
    v_cvt_pk_bf16_f32 v115, v110, v111
    s_nop 0
    v_permlane16_swap_b32 v112, v114
    v_permlane16_swap_b32 v113, v115
    buffer_store_dwordx4 v[112:115], v2, s[12:15], s40 offen offset:3072 sc1
    ds_read_b128 v[20:23], v5 offset:320
    ds_read_b128 v[24:27], v5 offset:768
    s_waitcnt lgkmcnt(2)
    v_pk_fma_f32 v[120:121], v[12:13], v[36:37], v[120:121] op_sel:[0,0,0] op_sel_hi:[1,0,1]
    v_pk_fma_f32 v[122:123], v[14:15], v[36:37], v[122:123] op_sel:[0,0,0] op_sel_hi:[1,0,1]
    v_pk_fma_f32 v[124:125], v[12:13], v[40:41], v[124:125] op_sel:[0,0,0] op_sel_hi:[1,0,1]
    v_pk_fma_f32 v[126:127], v[14:15], v[40:41], v[126:127] op_sel:[0,0,0] op_sel_hi:[1,0,1]
    v_pk_fma_f32 v[128:129], v[16:17], v[36:37], v[128:129] op_sel:[0,0,0] op_sel_hi:[1,0,1]
    v_pk_fma_f32 v[130:131], v[18:19], v[36:37], v[130:131] op_sel:[0,0,0] op_sel_hi:[1,0,1]
    v_pk_fma_f32 v[132:133], v[16:17], v[40:41], v[132:133] op_sel:[0,0,0] op_sel_hi:[1,0,1]
    v_pk_fma_f32 v[134:135], v[18:19], v[40:41], v[134:135] op_sel:[0,0,0] op_sel_hi:[1,0,1]
    v_pk_mul_f32 v[44:45], v[120:121], v[120:121]
    v_pk_mul_f32 v[46:47], v[122:123], v[122:123]
    v_pk_mul_f32 v[48:49], v[124:125], v[124:125]
    v_pk_mul_f32 v[50:51], v[126:127], v[126:127]
    v_pk_fma_f32 v[44:45], v[44:45], v[38:39], v[36:37] op_sel:[0,0,1] op_sel_hi:[1,0,1]
    v_pk_fma_f32 v[46:47], v[46:47], v[38:39], v[36:37] op_sel:[0,0,1] op_sel_hi:[1,0,1]
    v_pk_fma_f32 v[48:49], v[48:49], v[42:43], v[40:41] op_sel:[0,0,1] op_sel_hi:[1,0,1]
    v_pk_fma_f32 v[50:51], v[50:51], v[42:43], v[40:41] op_sel:[0,0,1] op_sel_hi:[1,0,1]
    v_pk_mul_f32 v[44:45], v[44:45], v[120:121]
    v_pk_mul_f32 v[46:47], v[46:47], v[122:123]
    v_pk_mul_f32 v[48:49], v[48:49], v[124:125]
    v_pk_mul_f32 v[50:51], v[50:51], v[126:127]
    v_exp_f32 v44, v44
    v_exp_f32 v45, v45
    v_exp_f32 v46, v46
    v_exp_f32 v47, v47
    v_exp_f32 v48, v48
    v_exp_f32 v49, v49
    v_exp_f32 v50, v50
    v_exp_f32 v51, v51
    v_pk_mul_f32 v[120:121], v[120:121], v[128:129]
    v_pk_mul_f32 v[122:123], v[122:123], v[130:131]
    v_pk_mul_f32 v[124:125], v[124:125], v[132:133]
    v_pk_mul_f32 v[126:127], v[126:127], v[134:135]
    v_pk_fma_f32 v[44:45], v[44:45], v[38:39], v[38:39] op_sel:[0,1,1] op_sel_hi:[1,1,1]
    v_pk_fma_f32 v[46:47], v[46:47], v[38:39], v[38:39] op_sel:[0,1,1] op_sel_hi:[1,1,1]
    v_pk_fma_f32 v[48:49], v[48:49], v[42:43], v[42:43] op_sel:[0,1,1] op_sel_hi:[1,1,1]
    v_pk_fma_f32 v[50:51], v[50:51], v[42:43], v[42:43] op_sel:[0,1,1] op_sel_hi:[1,1,1]
    v_rcp_f32 v44, v44
    v_rcp_f32 v45, v45
    v_rcp_f32 v46, v46
    v_rcp_f32 v47, v47
    v_rcp_f32 v48, v48
    v_rcp_f32 v49, v49
    v_rcp_f32 v50, v50
    v_rcp_f32 v51, v51
    v_pk_mul_f32 v[120:121], v[120:121], v[44:45]
    v_pk_mul_f32 v[122:123], v[122:123], v[46:47]
    v_pk_mul_f32 v[124:125], v[124:125], v[48:49]
    v_pk_mul_f32 v[126:127], v[126:127], v[50:51]
    v_cvt_pk_bf16_f32 v128, v120, v121
    v_cvt_pk_bf16_f32 v129, v122, v123
    v_cvt_pk_bf16_f32 v130, v124, v125
    v_cvt_pk_bf16_f32 v131, v126, v127
    s_nop 0
    v_permlane16_swap_b32 v128, v130
    v_permlane16_swap_b32 v129, v131
    buffer_store_dwordx4 v[128:131], v2, s[12:15], s41 offen offset:0 sc1
    ds_read_b128 v[12:15], v5 offset:384
    ds_read_b128 v[16:19], v5 offset:832
    s_waitcnt lgkmcnt(2)
    v_pk_fma_f32 v[136:137], v[20:21], v[36:37], v[136:137] op_sel:[0,0,0] op_sel_hi:[1,0,1]
    v_pk_fma_f32 v[138:139], v[22:23], v[36:37], v[138:139] op_sel:[0,0,0] op_sel_hi:[1,0,1]
    v_pk_fma_f32 v[140:141], v[20:21], v[40:41], v[140:141] op_sel:[0,0,0] op_sel_hi:[1,0,1]
    v_pk_fma_f32 v[142:143], v[22:23], v[40:41], v[142:143] op_sel:[0,0,0] op_sel_hi:[1,0,1]
    v_pk_fma_f32 v[144:145], v[24:25], v[36:37], v[144:145] op_sel:[0,0,0] op_sel_hi:[1,0,1]
    v_pk_fma_f32 v[146:147], v[26:27], v[36:37], v[146:147] op_sel:[0,0,0] op_sel_hi:[1,0,1]
    v_pk_fma_f32 v[148:149], v[24:25], v[40:41], v[148:149] op_sel:[0,0,0] op_sel_hi:[1,0,1]
    v_pk_fma_f32 v[150:151], v[26:27], v[40:41], v[150:151] op_sel:[0,0,0] op_sel_hi:[1,0,1]
    v_pk_mul_f32 v[44:45], v[136:137], v[136:137]
    v_pk_mul_f32 v[46:47], v[138:139], v[138:139]
    v_pk_mul_f32 v[48:49], v[140:141], v[140:141]
    v_pk_mul_f32 v[50:51], v[142:143], v[142:143]
    v_pk_fma_f32 v[44:45], v[44:45], v[38:39], v[36:37] op_sel:[0,0,1] op_sel_hi:[1,0,1]
    v_pk_fma_f32 v[46:47], v[46:47], v[38:39], v[36:37] op_sel:[0,0,1] op_sel_hi:[1,0,1]
    v_pk_fma_f32 v[48:49], v[48:49], v[42:43], v[40:41] op_sel:[0,0,1] op_sel_hi:[1,0,1]
    v_pk_fma_f32 v[50:51], v[50:51], v[42:43], v[40:41] op_sel:[0,0,1] op_sel_hi:[1,0,1]
    v_pk_mul_f32 v[44:45], v[44:45], v[136:137]
    v_pk_mul_f32 v[46:47], v[46:47], v[138:139]
    v_pk_mul_f32 v[48:49], v[48:49], v[140:141]
    v_pk_mul_f32 v[50:51], v[50:51], v[142:143]
    v_exp_f32 v44, v44
    v_exp_f32 v45, v45
    v_exp_f32 v46, v46
    v_exp_f32 v47, v47
    v_exp_f32 v48, v48
    v_exp_f32 v49, v49
    v_exp_f32 v50, v50
    v_exp_f32 v51, v51
    v_pk_mul_f32 v[136:137], v[136:137], v[144:145]
    v_pk_mul_f32 v[138:139], v[138:139], v[146:147]
    v_pk_mul_f32 v[140:141], v[140:141], v[148:149]
    v_pk_mul_f32 v[142:143], v[142:143], v[150:151]
    v_pk_fma_f32 v[44:45], v[44:45], v[38:39], v[38:39] op_sel:[0,1,1] op_sel_hi:[1,1,1]
    v_pk_fma_f32 v[46:47], v[46:47], v[38:39], v[38:39] op_sel:[0,1,1] op_sel_hi:[1,1,1]
    v_pk_fma_f32 v[48:49], v[48:49], v[42:43], v[42:43] op_sel:[0,1,1] op_sel_hi:[1,1,1]
    v_pk_fma_f32 v[50:51], v[50:51], v[42:43], v[42:43] op_sel:[0,1,1] op_sel_hi:[1,1,1]
    v_rcp_f32 v44, v44
    v_rcp_f32 v45, v45
    v_rcp_f32 v46, v46
    v_rcp_f32 v47, v47
    v_rcp_f32 v48, v48
    v_rcp_f32 v49, v49
    v_rcp_f32 v50, v50
    v_rcp_f32 v51, v51
    v_pk_mul_f32 v[136:137], v[136:137], v[44:45]
    v_pk_mul_f32 v[138:139], v[138:139], v[46:47]
    v_pk_mul_f32 v[140:141], v[140:141], v[48:49]
    v_pk_mul_f32 v[142:143], v[142:143], v[50:51]
    v_cvt_pk_bf16_f32 v144, v136, v137
    v_cvt_pk_bf16_f32 v145, v138, v139
    v_cvt_pk_bf16_f32 v146, v140, v141
    v_cvt_pk_bf16_f32 v147, v142, v143
    s_nop 0
    v_permlane16_swap_b32 v144, v146
    v_permlane16_swap_b32 v145, v147
    buffer_store_dwordx4 v[144:147], v2, s[12:15], s41 offen offset:1024 sc1
    s_waitcnt lgkmcnt(0)
    v_pk_fma_f32 v[152:153], v[12:13], v[36:37], v[152:153] op_sel:[0,0,0] op_sel_hi:[1,0,1]
    v_pk_fma_f32 v[154:155], v[14:15], v[36:37], v[154:155] op_sel:[0,0,0] op_sel_hi:[1,0,1]
    v_pk_fma_f32 v[156:157], v[12:13], v[40:41], v[156:157] op_sel:[0,0,0] op_sel_hi:[1,0,1]
    v_pk_fma_f32 v[158:159], v[14:15], v[40:41], v[158:159] op_sel:[0,0,0] op_sel_hi:[1,0,1]
    v_pk_fma_f32 v[160:161], v[16:17], v[36:37], v[160:161] op_sel:[0,0,0] op_sel_hi:[1,0,1]
    v_pk_fma_f32 v[162:163], v[18:19], v[36:37], v[162:163] op_sel:[0,0,0] op_sel_hi:[1,0,1]
    v_pk_fma_f32 v[164:165], v[16:17], v[40:41], v[164:165] op_sel:[0,0,0] op_sel_hi:[1,0,1]
    v_pk_fma_f32 v[166:167], v[18:19], v[40:41], v[166:167] op_sel:[0,0,0] op_sel_hi:[1,0,1]
    v_pk_mul_f32 v[44:45], v[152:153], v[152:153]
    v_pk_mul_f32 v[46:47], v[154:155], v[154:155]
    v_pk_mul_f32 v[48:49], v[156:157], v[156:157]
    v_pk_mul_f32 v[50:51], v[158:159], v[158:159]
    v_pk_fma_f32 v[44:45], v[44:45], v[38:39], v[36:37] op_sel:[0,0,1] op_sel_hi:[1,0,1]
    v_pk_fma_f32 v[46:47], v[46:47], v[38:39], v[36:37] op_sel:[0,0,1] op_sel_hi:[1,0,1]
    v_pk_fma_f32 v[48:49], v[48:49], v[42:43], v[40:41] op_sel:[0,0,1] op_sel_hi:[1,0,1]
    v_pk_fma_f32 v[50:51], v[50:51], v[42:43], v[40:41] op_sel:[0,0,1] op_sel_hi:[1,0,1]
    v_pk_mul_f32 v[44:45], v[44:45], v[152:153]
    v_pk_mul_f32 v[46:47], v[46:47], v[154:155]
    v_pk_mul_f32 v[48:49], v[48:49], v[156:157]
    v_pk_mul_f32 v[50:51], v[50:51], v[158:159]
    v_exp_f32 v44, v44
    v_exp_f32 v45, v45
    v_exp_f32 v46, v46
    v_exp_f32 v47, v47
    v_exp_f32 v48, v48
    v_exp_f32 v49, v49
    v_exp_f32 v50, v50
    v_exp_f32 v51, v51
    v_pk_mul_f32 v[152:153], v[152:153], v[160:161]
    v_pk_mul_f32 v[154:155], v[154:155], v[162:163]
    v_pk_mul_f32 v[156:157], v[156:157], v[164:165]
    v_pk_mul_f32 v[158:159], v[158:159], v[166:167]
    v_pk_fma_f32 v[44:45], v[44:45], v[38:39], v[38:39] op_sel:[0,1,1] op_sel_hi:[1,1,1]
    v_pk_fma_f32 v[46:47], v[46:47], v[38:39], v[38:39] op_sel:[0,1,1] op_sel_hi:[1,1,1]
    v_pk_fma_f32 v[48:49], v[48:49], v[42:43], v[42:43] op_sel:[0,1,1] op_sel_hi:[1,1,1]
    v_pk_fma_f32 v[50:51], v[50:51], v[42:43], v[42:43] op_sel:[0,1,1] op_sel_hi:[1,1,1]
    v_rcp_f32 v44, v44
    v_rcp_f32 v45, v45
    v_rcp_f32 v46, v46
    v_rcp_f32 v47, v47
    v_rcp_f32 v48, v48
    v_rcp_f32 v49, v49
    v_rcp_f32 v50, v50
    v_rcp_f32 v51, v51
    v_pk_mul_f32 v[152:153], v[152:153], v[44:45]
    v_pk_mul_f32 v[154:155], v[154:155], v[46:47]
    v_pk_mul_f32 v[156:157], v[156:157], v[48:49]
    v_pk_mul_f32 v[158:159], v[158:159], v[50:51]
    v_cvt_pk_bf16_f32 v160, v152, v153
    v_cvt_pk_bf16_f32 v161, v154, v155
    v_cvt_pk_bf16_f32 v162, v156, v157
    v_cvt_pk_bf16_f32 v163, v158, v159
    s_nop 0
    v_permlane16_swap_b32 v160, v162
    v_permlane16_swap_b32 v161, v163
    buffer_store_dwordx4 v[160:163], v2, s[12:15], s41 offen offset:2048 sc1
    v_mov_b32 v10, 1
    v_mov_b32 v11, 0
    s_waitcnt vmcnt(0)
    s_mov_b64 exec, 1
    buffer_store_dword v10, v11, s[12:15], s53 offen sc1
    s_mov_b64 exec, -1
    s_barrier
    s_and_b32 s10, s2, 7
    s_lshl_b32 s10, s10, 2
    s_bfe_u32 s11, s2, 0x20003
    s_add_u32 s25, s10, s11
    s_lshr_b32 s26, s2, 5
    v_and_b32 v2, 15, v1
    v_lshrrev_b32 v3, 4, v1
    s_lshr_b32 s33, s24, 1
    s_lshl_b32 s28, s25, 1
    s_add_u32 s28, s28, s33
    s_and_b32 s29, s24, 1
    s_lshl_b32 s33, s25, 6
    s_lshl_b32 s34, s24, 4
    s_add_u32 s43, s33, s34
    v_lshlrev_b32 v8, 9, v3
    v_lshl_add_u32 v8, v2, 4, v8
    s_lshr_b32 s33, s24, 1
    s_lshl_b32 s33, s33, 12
    s_lshl_b32 s34, s29, 8
    s_add_u32 s33, s33, s34
    v_add_u32 v8, s33, v8
    v_lshrrev_b32 v9, 1, v3
    v_lshlrev_b32 v9, 4, v9
    v_and_b32 v10, 1, v3
    v_lshl_add_u32 v9, v10, 2, v9
    v_bfe_u32 v10, v1, 2, 2
    v_add_u32 v9, v9, v10
    v_mul_u32_u24 v9, 160, v9
    v_and_b32 v10, 3, v1
    v_lshl_add_u32 v9, v10, 3, v9
    v_add_u32 v9, 8192, v9
    v_mov_b32 v10, v8
    v_mov_b32 v11, v9
    s_mov_b32 s37, 0
    s_mov_b32 s38, 0
    s_mul_i32 s33, s24, 2560
    s_add_u32 s33, s33, 153600
    v_lshrrev_b32 v5, 1, v3
    v_lshlrev_b32 v5, 8, v5
    v_lshl_add_u32 v5, v2, 4, v5
    v_and_b32 v6, 1, v3
    v_lshl_add_u32 v5, v6, 3, v5
    v_add_u32 v5, s33, v5
    v_lshl_add_u32 v140, v1, 4, s33
    v_mov_b32 v60, 0
    v_mov_b32 v61, 0
    v_mov_b32 v62, 0
    v_mov_b32 v63, 0
    v_mov_b32 v64, 0
    v_mov_b32 v65, 0
    v_mov_b32 v66, 0
    v_mov_b32 v67, 0
    v_mov_b32 v68, 0
    v_mov_b32 v69, 0
    v_mov_b32 v70, 0
    v_mov_b32 v71, 0
    v_mov_b32 v72, 0
    v_mov_b32 v73, 0
    v_mov_b32 v74, 0
    v_mov_b32 v75, 0
    v_mov_b32 v76, 0
    v_mov_b32 v77, 0
    v_mov_b32 v78, 0
    v_mov_b32 v79, 0
    s_mul_i32 s33, s24, 2816
    s_add_u32 s33, s33, 110592
    v_mul_u32_u24 v7, 176, v2
    v_lshl_add_u32 v7, v3, 3, v7
    v_add_u32 v7, s33, v7
    v_add_u32 v14, 0, v1
    v_mul_u32_u24 v15, 205, v14
    v_lshrrev_b32 v15, 11, v15
    v_lshlrev_b32 v14, 4, v14
    v_lshl_add_u32 v140, v15, 4, v14
    v_add_u32 v140, s33, v140
    v_mul_u32_u24 v15, 1120, v15
    v_add_u32 v144, v15, v14
    v_add_u32 v14, 64, v1
    v_mul_u32_u24 v15, 205, v14
    v_lshrrev_b32 v15, 11, v15
    v_lshlrev_b32 v14, 4, v14
    v_lshl_add_u32 v141, v15, 4, v14
    v_add_u32 v141, s33, v141
    v_mul_u32_u24 v15, 1120, v15
    v_add_u32 v145, v15, v14
    v_add_u32 v14, 128, v1
    v_mul_u32_u24 v15, 205, v14
    v_lshrrev_b32 v15, 11, v15
    v_lshlrev_b32 v14, 4, v14
    v_lshl_add_u32 v142, v15, 4, v14
    v_add_u32 v142, s33, v142
    v_mul_u32_u24 v15, 1120, v15
    v_add_u32 v146, v15, v14
    s_mul_i32 s41, s26, 160
    s_mul_i32 s34, s43, 1280
    s_add_u32 s41, s41, s34
    s_mov_b32 s20, s6
    s_mov_b32 s21, s7
    s_mov_b32 s22, 2621440
    s_mov_b32 s23, 0x20000
    s_barrier
    s_barrier
    ds_read_b128 v[12:15], v10 offset:0
    ds_read_b64_tr_b16 v[16:17], v11 offset:0
    ds_read_b64_tr_b16 v[18:19], v11 offset:1280
    ds_read_b64_tr_b16 v[20:21], v11 offset:32
    ds_read_b64_tr_b16 v[22:23], v11 offset:1312
    ds_read_b64_tr_b16 v[24:25], v11 offset:64
    ds_read_b64_tr_b16 v[26:27], v11 offset:1344
    ds_read_b64_tr_b16 v[28:29], v11 offset:96
    ds_read_b64_tr_b16 v[30:31], v11 offset:1376
    ds_read_b64_tr_b16 v[32:33], v11 offset:128
    ds_read_b64_tr_b16 v[34:35], v11 offset:1408
    ds_read_b128 v[36:39], v10 offset:2048
    ds_read_b64_tr_b16 v[40:41], v11 offset:5120
    ds_read_b64_tr_b16 v[42:43], v11 offset:6400
    ds_read_b64_tr_b16 v[44:45], v11 offset:5152
    ds_read_b64_tr_b16 v[46:47], v11 offset:6432
    ds_read_b64_tr_b16 v[48:49], v11 offset:5184
    ds_read_b64_tr_b16 v[50:51], v11 offset:6464
    ds_read_b64_tr_b16 v[52:53], v11 offset:5216
    ds_read_b64_tr_b16 v[54:55], v11 offset:6496
    ds_read_b64_tr_b16 v[56:57], v11 offset:5248
    ds_read_b64_tr_b16 v[58:59], v11 offset:6528
    s_add_u32 s37, s37, 18432
    s_cmp_lt_u32 s37, 110592
    s_cselect_b32 s37, s37, 0
    v_add_u32 v10, s37, v8
    v_add_u32 v11, s37, v9
.p2align 6
L_p5_loop:
    s_waitcnt lgkmcnt(0)
    s_barrier
    ds_read_b128 v[92:95], v10 offset:0
    ds_read_b64_tr_b16 v[96:97], v11 offset:0
    ds_read_b64_tr_b16 v[98:99], v11 offset:1280
    v_mfma_f32_16x16x32_bf16 v[60:63], v[16:19], v[12:15], v[60:63]
    ds_read_b64_tr_b16 v[100:101], v11 offset:32
    ds_read_b64_tr_b16 v[102:103], v11 offset:1312
    ds_read_b64_tr_b16 v[104:105], v11 offset:64
    v_mfma_f32_16x16x32_bf16 v[64:67], v[20:23], v[12:15], v[64:67]
    ds_read_b64_tr_b16 v[106:107], v11 offset:1344
    ds_read_b64_tr_b16 v[108:109], v11 offset:96
    ds_read_b64_tr_b16 v[110:111], v11 offset:1376
    v_mfma_f32_16x16x32_bf16 v[68:71], v[24:27], v[12:15], v[68:71]
    ds_read_b64_tr_b16 v[112:113], v11 offset:128
    ds_read_b64_tr_b16 v[114:115], v11 offset:1408
    ds_read_b128 v[116:119], v10 offset:2048
    v_mfma_f32_16x16x32_bf16 v[72:75], v[28:31], v[12:15], v[72:75]
    ds_read_b64_tr_b16 v[120:121], v11 offset:5120
    ds_read_b64_tr_b16 v[122:123], v11 offset:6400
    v_mfma_f32_16x16x32_bf16 v[76:79], v[32:35], v[12:15], v[76:79]
    ds_read_b64_tr_b16 v[124:125], v11 offset:5152
    ds_read_b64_tr_b16 v[126:127], v11 offset:6432
    v_mfma_f32_16x16x32_bf16 v[60:63], v[40:43], v[36:39], v[60:63]
    ds_read_b64_tr_b16 v[128:129], v11 offset:5184
    ds_read_b64_tr_b16 v[130:131], v11 offset:6464
    v_mfma_f32_16x16x32_bf16 v[64:67], v[44:47], v[36:39], v[64:67]
    ds_read_b64_tr_b16 v[132:133], v11 offset:5216
    ds_read_b64_tr_b16 v[134:135], v11 offset:6496
    v_mfma_f32_16x16x32_bf16 v[68:71], v[48:51], v[36:39], v[68:71]
    ds_read_b64_tr_b16 v[136:137], v11 offset:5248
    ds_read_b64_tr_b16 v[138:139], v11 offset:6528
    v_mfma_f32_16x16x32_bf16 v[72:75], v[52:55], v[36:39], v[72:75]
    v_mfma_f32_16x16x32_bf16 v[76:79], v[56:59], v[36:39], v[76:79]
    s_add_u32 s37, s37, 18432
    s_cmp_lt_u32 s37, 110592
    s_cselect_b32 s37, s37, 0
    v_add_u32 v10, s37, v8
    v_add_u32 v11, s37, v9
    s_add_u32 s38, s38, 1
    s_cmp_lt_u32 s38, 27
    s_cbranch_scc0 L_p5_done
    s_waitcnt lgkmcnt(0)
    s_barrier
    ds_read_b128 v[12:15], v10 offset:0
    ds_read_b64_tr_b16 v[16:17], v11 offset:0
    ds_read_b64_tr_b16 v[18:19], v11 offset:1280
    v_mfma_f32_16x16x32_bf16 v[60:63], v[96:99], v[92:95], v[60:63]
    ds_read_b64_tr_b16 v[20:21], v11 offset:32
    ds_read_b64_tr_b16 v[22:23], v11 offset:1312
    ds_read_b64_tr_b16 v[24:25], v11 offset:64
    v_mfma_f32_16x16x32_bf16 v[64:67], v[100:103], v[92:95], v[64:67]
    ds_read_b64_tr_b16 v[26:27], v11 offset:1344
    ds_read_b64_tr_b16 v[28:29], v11 offset:96
    ds_read_b64_tr_b16 v[30:31], v11 offset:1376
    v_mfma_f32_16x16x32_bf16 v[68:71], v[104:107], v[92:95], v[68:71]
    ds_read_b64_tr_b16 v[32:33], v11 offset:128
    ds_read_b64_tr_b16 v[34:35], v11 offset:1408
    ds_read_b128 v[36:39], v10 offset:2048
    v_mfma_f32_16x16x32_bf16 v[72:75], v[108:111], v[92:95], v[72:75]
    ds_read_b64_tr_b16 v[40:41], v11 offset:5120
    ds_read_b64_tr_b16 v[42:43], v11 offset:6400
    v_mfma_f32_16x16x32_bf16 v[76:79], v[112:115], v[92:95], v[76:79]
    ds_read_b64_tr_b16 v[44:45], v11 offset:5152
    ds_read_b64_tr_b16 v[46:47], v11 offset:6432
    v_mfma_f32_16x16x32_bf16 v[60:63], v[120:123], v[116:119], v[60:63]
    ds_read_b64_tr_b16 v[48:49], v11 offset:5184
    ds_read_b64_tr_b16 v[50:51], v11 offset:6464
    v_mfma_f32_16x16x32_bf16 v[64:67], v[124:127], v[116:119], v[64:67]
    ds_read_b64_tr_b16 v[52:53], v11 offset:5216
    ds_read_b64_tr_b16 v[54:55], v11 offset:6496
    v_mfma_f32_16x16x32_bf16 v[68:71], v[128:131], v[116:119], v[68:71]
    ds_read_b64_tr_b16 v[56:57], v11 offset:5248
    ds_read_b64_tr_b16 v[58:59], v11 offset:6528
    v_mfma_f32_16x16x32_bf16 v[72:75], v[132:135], v[116:119], v[72:75]
    v_mfma_f32_16x16x32_bf16 v[76:79], v[136:139], v[116:119], v[76:79]
    s_add_u32 s37, s37, 18432
    s_cmp_lt_u32 s37, 110592
    s_cselect_b32 s37, s37, 0
    v_add_u32 v10, s37, v8
    v_add_u32 v11, s37, v9
    s_add_u32 s38, s38, 1
    s_cmp_lt_u32 s38, 27
    s_cbranch_scc1 L_p5_loop
L_p5_done:
    ds_read_b64 v[80:81], v5 offset:0
    ds_read_b64 v[82:83], v5 offset:512
    ds_read_b64 v[84:85], v5 offset:1024
    ds_read_b64 v[86:87], v5 offset:1536
    ds_read_b64 v[88:89], v5 offset:2048
    s_nop 2
    s_waitcnt lgkmcnt(0)
    v_lshlrev_b32 v12, 16, v80
    v_and_b32 v13, 0xffff0000, v80
    v_pk_add_f32 v[60:61], v[60:61], v[12:13]
    v_lshlrev_b32 v12, 16, v81
    v_and_b32 v13, 0xffff0000, v81
    v_pk_add_f32 v[62:63], v[62:63], v[12:13]
    v_cvt_pk_bf16_f32 v60, v60, v61
    v_cvt_pk_bf16_f32 v61, v62, v63
    ds_write_b64 v7, v[60:61] offset:0
    v_lshlrev_b32 v12, 16, v82
    v_and_b32 v13, 0xffff0000, v82
    v_pk_add_f32 v[64:65], v[64:65], v[12:13]
    v_lshlrev_b32 v12, 16, v83
    v_and_b32 v13, 0xffff0000, v83
    v_pk_add_f32 v[66:67], v[66:67], v[12:13]
    v_cvt_pk_bf16_f32 v64, v64, v65
    v_cvt_pk_bf16_f32 v65, v66, v67
    ds_write_b64 v7, v[64:65] offset:32
    v_lshlrev_b32 v12, 16, v84
    v_and_b32 v13, 0xffff0000, v84
    v_pk_add_f32 v[68:69], v[68:69], v[12:13]
    v_lshlrev_b32 v12, 16, v85
    v_and_b32 v13, 0xffff0000, v85
    v_pk_add_f32 v[70:71], v[70:71], v[12:13]
    v_cvt_pk_bf16_f32 v68, v68, v69
    v_cvt_pk_bf16_f32 v69, v70, v71
    ds_write_b64 v7, v[68:69] offset:64
    v_lshlrev_b32 v12, 16, v86
    v_and_b32 v13, 0xffff0000, v86
    v_pk_add_f32 v[72:73], v[72:73], v[12:13]
    v_lshlrev_b32 v12, 16, v87
    v_and_b32 v13, 0xffff0000, v87
    v_pk_add_f32 v[74:75], v[74:75], v[12:13]
    v_cvt_pk_bf16_f32 v72, v72, v73
    v_cvt_pk_bf16_f32 v73, v74, v75
    ds_write_b64 v7, v[72:73] offset:96
    v_lshlrev_b32 v12, 16, v88
    v_and_b32 v13, 0xffff0000, v88
    v_pk_add_f32 v[76:77], v[76:77], v[12:13]
    v_lshlrev_b32 v12, 16, v89
    v_and_b32 v13, 0xffff0000, v89
    v_pk_add_f32 v[78:79], v[78:79], v[12:13]
    v_cvt_pk_bf16_f32 v76, v76, v77
    v_cvt_pk_bf16_f32 v77, v78, v79
    ds_write_b64 v7, v[76:77] offset:128
    s_waitcnt lgkmcnt(0)
    ds_read_b128 v[24:27], v140
    ds_read_b128 v[28:31], v141
    ds_read_b128 v[32:35], v142
    s_waitcnt lgkmcnt(2)
    buffer_store_dwordx4 v[24:27], v144, s[20:23], s41 offen
    s_waitcnt lgkmcnt(1)
    buffer_store_dwordx4 v[28:31], v145, s[20:23], s41 offen
    s_waitcnt lgkmcnt(0)
    s_mov_b32 exec_hi, 0
    buffer_store_dwordx4 v[32:35], v146, s[20:23], s41 offen
L_kf_end:
    s_endpgm
k3_kernel_codeend:
.section .rodata,"a"
.p2align 6
.amdhsa_kernel k1_kernel
  .amdhsa_next_free_vgpr 168
  .amdhsa_next_free_sgpr 100
  .amdhsa_accum_offset 168
  .amdhsa_group_segment_fixed_size 0
  .amdhsa_kernarg_size 80
  .amdhsa_user_sgpr_count 2
  .amdhsa_user_sgpr_kernarg_segment_ptr 1
  .amdhsa_system_sgpr_workgroup_id_x 1
.end_amdhsa_kernel
.p2align 6
.amdhsa_kernel k2_kernel
  .amdhsa_next_free_vgpr 164
  .amdhsa_next_free_sgpr 100
  .amdhsa_accum_offset 164
  .amdhsa_group_segment_fixed_size 0
  .amdhsa_kernarg_size 80
  .amdhsa_user_sgpr_count 2
  .amdhsa_user_sgpr_kernarg_segment_ptr 1
  .amdhsa_system_sgpr_workgroup_id_x 1
.end_amdhsa_kernel
.p2align 6
.amdhsa_kernel k3_kernel
  .amdhsa_next_free_vgpr 168
  .amdhsa_next_free_sgpr 100
  .amdhsa_accum_offset 168
  .amdhsa_group_segment_fixed_size 0
  .amdhsa_kernarg_size 80
  .amdhsa_user_sgpr_count 2
  .amdhsa_user_sgpr_kernarg_segment_ptr 1
  .amdhsa_system_sgpr_workgroup_id_x 1
.end_amdhsa_kernel
```
